```python
import torch

def _softmax(x, axis=-1):
    return torch.softmax(x, dim=axis)
def _gelu(x):
    return torch.nn.functional.gelu(x, approximate="tanh")
def _silu(x):
    return torch.nn.functional.silu(x)
def _sigmoid(x):
    return torch.sigmoid(x)
def _layernorm(x, axis=-1, eps=1e-5):
    m = x.mean(dim=axis, keepdim=True)
    v = x.var(dim=axis, keepdim=True, unbiased=False)
    return (x - m) / torch.sqrt(v + eps)
def _scatter_add(tgt, idx, src, axis=0):
    return tgt.clone().index_add_(axis, idx, src)
def _segment_sum(src, seg, n):
    out = torch.zeros((n,) + src.shape[1:], dtype=src.dtype)
    return out.index_add_(0, seg, src)
def _pad(x, pw):
    flat = tuple(v for pair in reversed(pw) for v in pair)
    return torch.nn.functional.pad(x, flat)

kernel_name = 'sequential_preLN__gqa_block_cached__mixer_token_mlp__decode'

def setup_inputs():

    _w = (lambda a: (lambda t: t.to(torch.bfloat16) if t.is_floating_point() else t)(torch.as_tensor(a)))
    def _A_setup():
        B, Sq, D = 2, 1, 576
        Hq, Hkv, Sk, Dh = 32, 16, 8192, 128
        assert Hq % Hkv == 0, (Hq, Hkv)
        return {
            "x": _w((lambda *s: torch.randn(*s, dtype=torch.bfloat16) * 0.1)(B, Sq, D)),
            "k_cache": _w((lambda *s: torch.randn(*s, dtype=torch.bfloat16) * 1.6)(B, Hkv, Sk, Dh)),
            "v_cache": _w((lambda *s: torch.randn(*s, dtype=torch.bfloat16) * 1.6)(B, Hkv, Sk, Dh)),
            "wq": _w((lambda *s: torch.randn(*s, dtype=torch.bfloat16) * 1.6)(D, Hq * Dh) * (D ** -0.5)),
            "wo": _w((lambda *s: torch.randn(*s, dtype=torch.bfloat16) * 1.6)(Hq * Dh, D) * ((Hq * Dh) ** -0.5)),
        }
    _A_in = _A_setup()

    def _B_setup():
        B, S, D, F = 2, 1, 576, 4608
        return {
            "x": _w((lambda *s: torch.randn(*s, dtype=torch.bfloat16) * 0.1)(B, S, D)),
            "w1": _w((lambda *s: torch.randn(*s, dtype=torch.bfloat16) * 3.2)(S, F) * (S ** -0.5)),
            "b1": _w((lambda *s: torch.randn(*s, dtype=torch.bfloat16) * 3.2)(F) * 0.02),
            "w2": _w((lambda *s: torch.randn(*s, dtype=torch.bfloat16) * 0.8)(F, S) * (F ** -0.5)),
            "b2": _w((lambda *s: torch.randn(*s, dtype=torch.bfloat16) * 0.8)(S) * 0.02),
        }
    _B_in = _B_setup()

    return {
        "A_x": _A_in["x"],
        "A_k_cache": _A_in["k_cache"],
        "A_v_cache": _A_in["v_cache"],
        "A_wq": _A_in["wq"],
        "A_wo": _A_in["wo"],
        "B_x": _B_in["x"],
        "B_w1": _B_in["w1"],
        "B_b1": _B_in["b1"],
        "B_w2": _B_in["w2"],
        "B_b2": _B_in["b2"],
    }

def reference(A_x, A_k_cache, A_v_cache, A_wq, A_wo, B_x, B_w1, B_b1, B_w2, B_b2):
    def _A_ref(x, k_cache, v_cache, wq, wo):
        B, Sq, D = x.shape
        Hq, Dh = 32, 128
        Hkv = k_cache.shape[1]
        rep = Hq // Hkv
        q = (lambda x, *d: x.permute(*d))((x @ wq).reshape(B, Sq, Hq, Dh), 0, 2, 1, 3)
        k = (lambda x, n, axis: torch.repeat_interleave(x, n, dim=axis))(k_cache, rep, axis=1)
        v = (lambda x, n, axis: torch.repeat_interleave(x, n, dim=axis))(v_cache, rep, axis=1)
        scores = torch.einsum("bhqd,bhkd->bhqk", q, k) * (Dh ** -0.5)
        p = _softmax(scores, axis=-1)
        o = torch.einsum("bhqk,bhkd->bhqd", p, v)
        return (lambda x, *d: x.permute(*d))(o, 0, 2, 1, 3).reshape(B, Sq, Hq * Dh) @ wo

    def _B_ref(x, w1, b1, w2, b2):
        B, S, D = x.shape
        h = _layernorm(x, axis=-1)
        u = torch.einsum("bsd,sf->bdf", h, w1) + b1
        u = _gelu(u)
        y = torch.einsum("bdf,fs->bds", u, w2) + b2
        return (lambda x, *d: x.permute(*d))(y, 0, 2, 1)

    x = A_x
    h = x + _A_ref(_layernorm(x, axis=-1), A_k_cache, A_v_cache, A_wq, A_wo)
    h2 = h + _B_ref(_layernorm(h, axis=-1), B_w1, B_b1, B_w2, B_b2)
    return h2
```

```asm
; @launch grid=(256,1,1) block=(512,1,1) lds=40960
.amdgcn_target "amdgcn-amd-amdhsa--gfx950"
.text
.globl sequential_preLN__gqa_block_cached__mixer_token_mlp__decode_kernel
.p2align 8
.type sequential_preLN__gqa_block_cached__mixer_token_mlp__decode_kernel,@function
sequential_preLN__gqa_block_cached__mixer_token_mlp__decode_kernel:
    s_cmp_ge_u32 s2, 256
    s_cbranch_scc1 L_end
    s_load_dwordx8 s[4:11], s[0:1], 0
    s_load_dwordx2 s[28:29], s[0:1], 96
    s_load_dwordx4 s[12:15], s[0:1], 32
    s_load_dwordx8 s[16:23], s[0:1], 48
    s_load_dwordx4 s[24:27], s[0:1], 80
    v_mov_b32 v4, 0
    v_mov_b32 v5, 0
    v_mov_b32 v6, 0
    v_mov_b32 v7, 0
    ds_write_b128 v4, v[4:7]
    ds_write_b128 v4, v[4:7] offset:16
    ds_write_b128 v4, v[4:7] offset:32
    v_lshrrev_b32 v1, 6, v0
    v_and_b32 v0, 63, v0
    v_readfirstlane_b32 s35, v1
    s_and_b32 s63, s2, 7
    s_lshr_b32 s64, s2, 3
    s_lshr_b32 s30, s64, 4
    s_lshl1_add_u32 s30, s63, s30
    s_bfe_u32 s31, s64, 0x10003
    s_and_b32 s32, s64, 7
    s_lshl1_add_u32 s33, s30, s31
    s_lshl_b32 s34, s33, 3
    s_add_u32 s34, s34, s32
    s_and_b32 s3, s35, 3
    s_cmp_ge_u32 s35, 4
    s_cbranch_scc1 L_stream
    s_cmp_eq_u32 s35, 0
    s_cbranch_scc1 L_h0a
    s_waitcnt lgkmcnt(0)
    s_barrier
    s_branch L_helper
L_h0a:
    s_setprio 3
    v_lshrrev_b32 v13, 5, v0
    v_mul_u32_u24 v13, 1152, v13
    v_and_b32 v2, 31, v0
    v_lshl_add_u32 v13, v2, 2, v13
    s_lshl1_add_u32 s63, s30, s31
    s_lshl_b32 s63, s63, 8
    s_mul_i32 s64, s32, 589824
    s_add_u32 s63, s63, s64
    v_lshrrev_b32 v2, 4, v0
    v_lshlrev_b32 v2, 13, v2
    v_and_b32 v3, 15, v0
    v_lshl_add_u32 v2, v3, 4, v2
    s_mov_b32 s66, 0
    s_mov_b32 s67, 0x8000
    s_waitcnt lgkmcnt(0)
    s_mov_b32 s48, s4
    s_and_b32 s49, s5, 0xffff
    s_mov_b32 s50, 2304
    s_mov_b32 s51, 0x20000
    buffer_load_dword v14, v13, s[48:51], 0 offen offset:0
    buffer_load_dword v15, v13, s[48:51], 0 offen offset:128
    buffer_load_dword v16, v13, s[48:51], 0 offen offset:256
    buffer_load_dword v17, v13, s[48:51], 0 offen offset:384
    buffer_load_dword v18, v13, s[48:51], 0 offen offset:512
    buffer_load_dword v19, v13, s[48:51], 0 offen offset:640
    buffer_load_dword v20, v13, s[48:51], 0 offen offset:768
    buffer_load_dword v21, v13, s[48:51], 0 offen offset:896
    buffer_load_dword v22, v13, s[48:51], 0 offen offset:1024
    s_barrier
    s_sub_u32 s64, 4718592, s63
    s_add_u32 s52, s10, s63
    s_addc_u32 s53, s11, 0
    s_and_b32 s53, s53, 0xffff
    s_mov_b32 s54, s64
    s_mov_b32 s55, 0x20000
    buffer_load_dwordx4 a[0:3], v2, s[52:55], s66 offen nt
    s_add_u32 s66, s66, s67
    buffer_load_dwordx4 a[4:7], v2, s[52:55], s66 offen nt
    s_add_u32 s66, s66, s67
    buffer_load_dwordx4 a[8:11], v2, s[52:55], s66 offen nt
    s_add_u32 s66, s66, s67
    buffer_load_dwordx4 a[12:15], v2, s[52:55], s66 offen nt
    s_add_u32 s66, s66, s67
    buffer_load_dwordx4 a[16:19], v2, s[52:55], s66 offen nt
    s_add_u32 s66, s66, s67
    buffer_load_dwordx4 a[20:23], v2, s[52:55], s66 offen nt
    s_add_u32 s66, s66, s67
    buffer_load_dwordx4 a[24:27], v2, s[52:55], s66 offen nt
    s_add_u32 s66, s66, s67
    buffer_load_dwordx4 a[28:31], v2, s[52:55], s66 offen nt
    s_add_u32 s66, s66, s67
    buffer_load_dwordx4 a[32:35], v2, s[52:55], s66 offen nt
    s_add_u32 s66, s66, s67
    buffer_load_dwordx4 a[36:39], v2, s[52:55], s66 offen nt
    s_add_u32 s66, s66, s67
    buffer_load_dwordx4 a[40:43], v2, s[52:55], s66 offen nt
    s_add_u32 s66, s66, s67
    buffer_load_dwordx4 a[44:47], v2, s[52:55], s66 offen nt
    s_add_u32 s66, s66, s67
    buffer_load_dwordx4 a[48:51], v2, s[52:55], s66 offen nt
    s_add_u32 s66, s66, s67
    buffer_load_dwordx4 a[52:55], v2, s[52:55], s66 offen nt
    s_add_u32 s66, s66, s67
    buffer_load_dwordx4 a[56:59], v2, s[52:55], s66 offen nt
    s_add_u32 s66, s66, s67
    buffer_load_dwordx4 a[60:63], v2, s[52:55], s66 offen nt
    s_add_u32 s66, s66, s67
    buffer_load_dwordx4 a[64:67], v2, s[52:55], s66 offen nt
    s_add_u32 s66, s66, s67
    buffer_load_dwordx4 a[68:71], v2, s[52:55], s66 offen nt
    s_add_u32 s66, s66, s67
    s_branch L_h0
L_stream:
    s_setprio 2
    s_lshl_b32 s63, s31, 4
    s_add_u32 s63, s63, s30
    s_lshl_b32 s63, s63, 3
    s_add_u32 s63, s63, s32
    s_lshl_b32 s63, s63, 18
    s_lshl_b32 s64, s3, 10
    v_lshlrev_b32 v2, 4, v0
    v_add_u32 v2, s64, v2
    v_and_b32 v19, 3, v0
    v_lshlrev_b32 v19, 4, v19
    v_bfe_u32 v20, v0, 2, 2
    v_lshl_add_u32 v19, v20, 8, v19
    v_lshrrev_b32 v20, 4, v0
    v_lshl_add_u32 v19, v20, 6, v19
    v_add_u32 v1, s64, v19
    s_mov_b32 s66, 0
    s_mov_b32 s67, 0
    s_movk_i32 s68, 0x1000
    s_waitcnt lgkmcnt(0)
    s_add_u32 s36, s6, s63
    s_addc_u32 s37, s7, 0
    s_and_b32 s37, s37, 0xffff
    s_mov_b32 s38, 262144
    s_mov_b32 s39, 0x20000
    s_add_u32 s40, s8, s63
    s_addc_u32 s41, s9, 0
    s_and_b32 s41, s41, 0xffff
    s_mov_b32 s42, 262144
    s_mov_b32 s43, 0x20000
    s_barrier
    buffer_load_dwordx4 a[0:3], v1, s[36:39], s66 offen nt
    s_add_u32 s66, s66, s68
    buffer_load_dwordx4 a[4:7], v1, s[36:39], s66 offen nt
    s_add_u32 s66, s66, s68
    buffer_load_dwordx4 a[8:11], v1, s[36:39], s66 offen nt
    s_add_u32 s66, s66, s68
    buffer_load_dwordx4 a[12:15], v1, s[36:39], s66 offen nt
    s_add_u32 s66, s66, s68
    buffer_load_dwordx4 a[16:19], v1, s[36:39], s66 offen nt
    s_add_u32 s66, s66, s68
    buffer_load_dwordx4 a[20:23], v1, s[36:39], s66 offen nt
    s_add_u32 s66, s66, s68
    buffer_load_dwordx4 a[24:27], v1, s[36:39], s66 offen nt
    s_add_u32 s66, s66, s68
    s_branch L_stream2
L_h0:
    s_load_dword s56, s[28:29], 0
    s_load_dword s68, s[22:23], 0
    s_mov_b32 s44, s28
    s_and_b32 s45, s29, 0xffff
    s_mov_b32 s46, 4194304
    s_mov_b32 s47, 0x20000
    v_and_b32 v2, 1, v0
    v_lshlrev_b32 v2, 4, v2
    v_mov_b32 v3, 0xffff
    v_lshlrev_b32 v2, v2, v3
    v_bfe_u32 v3, v0, 1, 2
    v_cmp_eq_u32 vcc, 0, v3
    s_nop 1
    v_cndmask_b32 v8, 0, v2, vcc
    v_cmp_eq_u32 vcc, 1, v3
    s_nop 1
    v_cndmask_b32 v9, 0, v2, vcc
    v_cmp_eq_u32 vcc, 2, v3
    s_nop 1
    v_cndmask_b32 v10, 0, v2, vcc
    v_cmp_eq_u32 vcc, 3, v3
    s_nop 1
    v_cndmask_b32 v11, 0, v2, vcc
    s_waitcnt vmcnt(18)
    v_and_b32 v33, 0xffff0000, v14
    v_lshlrev_b32 v32, 16, v14
    v_and_b32 v35, 0xffff0000, v15
    v_lshlrev_b32 v34, 16, v15
    v_and_b32 v37, 0xffff0000, v16
    v_lshlrev_b32 v36, 16, v16
    v_and_b32 v39, 0xffff0000, v17
    v_lshlrev_b32 v38, 16, v17
    v_and_b32 v41, 0xffff0000, v18
    v_lshlrev_b32 v40, 16, v18
    v_and_b32 v43, 0xffff0000, v19
    v_lshlrev_b32 v42, 16, v19
    v_and_b32 v45, 0xffff0000, v20
    v_lshlrev_b32 v44, 16, v20
    v_and_b32 v47, 0xffff0000, v21
    v_lshlrev_b32 v46, 16, v21
    v_and_b32 v49, 0xffff0000, v22
    v_lshlrev_b32_e64 v48, 16, v22
    v_pk_add_f32 v[4:5], v[32:33], v[34:35]
    v_pk_add_f32 v[4:5], v[4:5], v[36:37]
    v_pk_add_f32 v[4:5], v[4:5], v[38:39]
    v_pk_add_f32 v[4:5], v[4:5], v[40:41]
    v_pk_add_f32 v[4:5], v[4:5], v[42:43]
    v_pk_add_f32 v[4:5], v[4:5], v[44:45]
    v_pk_add_f32 v[4:5], v[4:5], v[46:47]
    v_pk_add_f32 v[4:5], v[4:5], v[48:49]
    v_add_f32 v4, v4, v5
    s_nop 1
    v_add_f32_dpp v4, v4, v4 quad_perm:[1,0,3,2] row_mask:0xf bank_mask:0xf
    s_nop 1
    v_add_f32_dpp v4, v4, v4 quad_perm:[2,3,0,1] row_mask:0xf bank_mask:0xf
    s_nop 1
    v_add_f32_dpp v4, v4, v4 row_half_mirror row_mask:0xf bank_mask:0xf
    s_nop 1
    v_add_f32_dpp v4, v4, v4 row_mirror row_mask:0xf bank_mask:0xf
    v_mov_b32 v5, v4
    s_nop 1
    v_permlane16_swap_b32 v4, v5
    v_add_f32_e64 v4, v4, v5
    v_mul_f32 v4, 0x3ae38e39, v4
    v_pk_add_f32 v[52:53], v[32:33], v[4:5] op_sel_hi:[1,0] neg_lo:[0,1] neg_hi:[0,1]
    v_pk_add_f32 v[54:55], v[34:35], v[4:5] op_sel_hi:[1,0] neg_lo:[0,1] neg_hi:[0,1]
    v_pk_add_f32 v[56:57], v[36:37], v[4:5] op_sel_hi:[1,0] neg_lo:[0,1] neg_hi:[0,1]
    v_pk_add_f32 v[58:59], v[38:39], v[4:5] op_sel_hi:[1,0] neg_lo:[0,1] neg_hi:[0,1]
    v_pk_add_f32 v[60:61], v[40:41], v[4:5] op_sel_hi:[1,0] neg_lo:[0,1] neg_hi:[0,1]
    v_pk_add_f32 v[62:63], v[42:43], v[4:5] op_sel_hi:[1,0] neg_lo:[0,1] neg_hi:[0,1]
    v_pk_add_f32 v[64:65], v[44:45], v[4:5] op_sel_hi:[1,0] neg_lo:[0,1] neg_hi:[0,1]
    v_pk_add_f32 v[66:67], v[46:47], v[4:5] op_sel_hi:[1,0] neg_lo:[0,1] neg_hi:[0,1]
    v_pk_add_f32 v[68:69], v[48:49], v[4:5] op_sel_hi:[1,0] neg_lo:[0,1] neg_hi:[0,1]
    v_pk_mul_f32 v[6:7], v[52:53], v[52:53]
    v_pk_fma_f32 v[6:7], v[54:55], v[54:55], v[6:7]
    v_pk_fma_f32 v[6:7], v[56:57], v[56:57], v[6:7]
    v_pk_fma_f32 v[6:7], v[58:59], v[58:59], v[6:7]
    v_pk_fma_f32 v[6:7], v[60:61], v[60:61], v[6:7]
    v_pk_fma_f32 v[6:7], v[62:63], v[62:63], v[6:7]
    v_pk_fma_f32 v[6:7], v[64:65], v[64:65], v[6:7]
    v_pk_fma_f32 v[6:7], v[66:67], v[66:67], v[6:7]
    v_pk_fma_f32 v[6:7], v[68:69], v[68:69], v[6:7]
    v_add_f32 v6, v6, v7
    s_nop 1
    v_add_f32_dpp v6, v6, v6 quad_perm:[1,0,3,2] row_mask:0xf bank_mask:0xf
    s_nop 1
    v_add_f32_dpp v6, v6, v6 quad_perm:[2,3,0,1] row_mask:0xf bank_mask:0xf
    s_nop 1
    v_add_f32_dpp v6, v6, v6 row_half_mirror row_mask:0xf bank_mask:0xf
    s_nop 1
    v_add_f32_dpp v6, v6, v6 row_mirror row_mask:0xf bank_mask:0xf
    v_mov_b32 v7, v6
    s_nop 1
    v_permlane16_swap_b32 v6, v7
    v_add_f32_e64 v6, v6, v7
    v_mul_f32 v6, 0x3ae38e39, v6
    v_cvt_pk_bf16_f32 v4, v4, v4
    v_and_b32 v4, 0xffff0000, v4
    v_cvt_pk_bf16_f32 v6, v6, v6
    v_and_b32 v6, 0xffff0000, v6
    v_add_f32 v6, 0x3727c5ac, v6
    v_cvt_pk_bf16_f32 v6, v6, v6
    v_and_b32 v6, 0xffff0000, v6
    v_sqrt_f32 v6, v6
    s_nop 0
    v_cvt_pk_bf16_f32 v6, v6, v6
    v_and_b32 v6, 0xffff0000, v6
    v_rcp_f32_e64 v6, v6
    v_pk_add_f32 v[52:53], v[32:33], v[4:5] op_sel_hi:[1,0] neg_lo:[0,1] neg_hi:[0,1]
    v_pk_add_f32 v[54:55], v[34:35], v[4:5] op_sel_hi:[1,0] neg_lo:[0,1] neg_hi:[0,1]
    v_pk_add_f32 v[56:57], v[36:37], v[4:5] op_sel_hi:[1,0] neg_lo:[0,1] neg_hi:[0,1]
    v_pk_add_f32 v[58:59], v[38:39], v[4:5] op_sel_hi:[1,0] neg_lo:[0,1] neg_hi:[0,1]
    v_pk_add_f32 v[60:61], v[40:41], v[4:5] op_sel_hi:[1,0] neg_lo:[0,1] neg_hi:[0,1]
    v_pk_add_f32 v[62:63], v[42:43], v[4:5] op_sel_hi:[1,0] neg_lo:[0,1] neg_hi:[0,1]
    v_pk_add_f32 v[64:65], v[44:45], v[4:5] op_sel_hi:[1,0] neg_lo:[0,1] neg_hi:[0,1]
    v_pk_add_f32 v[66:67], v[46:47], v[4:5] op_sel_hi:[1,0] neg_lo:[0,1] neg_hi:[0,1]
    v_pk_add_f32 v[68:69], v[48:49], v[4:5] op_sel_hi:[1,0] neg_lo:[0,1] neg_hi:[0,1]
    v_cvt_pk_bf16_f32 v14, v52, v53
    v_cvt_pk_bf16_f32 v15, v54, v55
    v_cvt_pk_bf16_f32 v16, v56, v57
    v_cvt_pk_bf16_f32 v17, v58, v59
    v_cvt_pk_bf16_f32 v18, v60, v61
    v_cvt_pk_bf16_f32 v19, v62, v63
    v_cvt_pk_bf16_f32 v20, v64, v65
    v_cvt_pk_bf16_f32 v21, v66, v67
    v_cvt_pk_bf16_f32 v22, v68, v69
    v_and_b32 v53, 0xffff0000, v14
    v_lshlrev_b32 v52, 16, v14
    v_and_b32 v55, 0xffff0000, v15
    v_lshlrev_b32 v54, 16, v15
    v_and_b32 v57, 0xffff0000, v16
    v_lshlrev_b32 v56, 16, v16
    v_and_b32 v59, 0xffff0000, v17
    v_lshlrev_b32 v58, 16, v17
    v_and_b32 v61, 0xffff0000, v18
    v_lshlrev_b32 v60, 16, v18
    v_and_b32 v63, 0xffff0000, v19
    v_lshlrev_b32 v62, 16, v19
    v_and_b32 v65, 0xffff0000, v20
    v_lshlrev_b32 v64, 16, v20
    v_and_b32 v67, 0xffff0000, v21
    v_lshlrev_b32 v66, 16, v21
    v_and_b32 v69, 0xffff0000, v22
    v_lshlrev_b32_e64 v68, 16, v22
    v_pk_mul_f32 v[52:53], v[52:53], v[6:7] op_sel_hi:[1,0]
    v_pk_mul_f32 v[54:55], v[54:55], v[6:7] op_sel_hi:[1,0]
    v_pk_mul_f32 v[56:57], v[56:57], v[6:7] op_sel_hi:[1,0]
    v_pk_mul_f32 v[58:59], v[58:59], v[6:7] op_sel_hi:[1,0]
    v_pk_mul_f32 v[60:61], v[60:61], v[6:7] op_sel_hi:[1,0]
    v_pk_mul_f32 v[62:63], v[62:63], v[6:7] op_sel_hi:[1,0]
    v_pk_mul_f32 v[64:65], v[64:65], v[6:7] op_sel_hi:[1,0]
    v_pk_mul_f32 v[66:67], v[66:67], v[6:7] op_sel_hi:[1,0]
    v_pk_mul_f32 v[68:69], v[68:69], v[6:7] op_sel_hi:[1,0]
    v_cvt_pk_bf16_f32 v14, v52, v53
    v_cvt_pk_bf16_f32 v15, v54, v55
    v_cvt_pk_bf16_f32 v16, v56, v57
    v_cvt_pk_bf16_f32 v17, v58, v59
    v_cvt_pk_bf16_f32 v18, v60, v61
    v_cvt_pk_bf16_f32 v19, v62, v63
    v_cvt_pk_bf16_f32 v20, v64, v65
    v_cvt_pk_bf16_f32 v21, v66, v67
    v_cvt_pk_bf16_f32 v22, v68, v69
    ds_write_b32 v13, v14 offset:640
    ds_write_b32 v13, v15 offset:768
    ds_write_b32 v13, v16 offset:896
    ds_write_b32 v13, v17 offset:1024
    ds_write_b32 v13, v18 offset:1152
    ds_write_b32 v13, v19 offset:1280
    ds_write_b32 v13, v20 offset:1408
    ds_write_b32 v13, v21 offset:1536
    ds_write_b32 v13, v22 offset:1664
    v_bfe_u32 v1, v0, 3, 1
    v_mul_u32_u24 v1, 1152, v1
    v_lshrrev_b32 v2, 4, v0
    v_lshl_add_u32 v1, v2, 1, v1
    s_mul_i32 s63, s32, 144
    v_add_u32 v1, s63, v1
    s_waitcnt lgkmcnt(0)
    v_mov_b32 v2, 0
    v_mov_b32_e64 v3, 1
    ds_write_b32 v2, v3 offset:36
    ds_read_u16 v32, v1 offset:640
    ds_read_u16 v33, v1 offset:648
    ds_read_u16 v34, v1 offset:656
    ds_read_u16 v35, v1 offset:664
    ds_read_u16 v36, v1 offset:672
    ds_read_u16 v37, v1 offset:680
    ds_read_u16 v38, v1 offset:688
    ds_read_u16 v39, v1 offset:696
    ds_read_u16 v40, v1 offset:704
    ds_read_u16 v41, v1 offset:712
    ds_read_u16 v42, v1 offset:720
    ds_read_u16 v43, v1 offset:728
    ds_read_u16 v44, v1 offset:736
    ds_read_u16 v45, v1 offset:744
    ds_read_u16 v46, v1 offset:752
    ds_read_u16 v47, v1 offset:760
    ds_read_u16 v48, v1 offset:768
    ds_read_u16 v49, v1 offset:776
    s_and_b32 s63, s56, 0x7f7f7f7f
    s_add_u32 s63, s63, 0x01010101
    s_and_b32 s56, s56, 0x80808080
    s_xor_b32 s56, s56, s63
    s_bfe_u32 s57, s56, 0x80000
    s_bfe_u32 s58, s56, 0x80008
    s_bfe_u32 s59, s56, 0x80010
    s_bfe_u32 s60, s56, 0x80018
    v_mov_b32 v12, 0xffffff00
    v_lshrrev_b32 v1, 5, v0
    v_lshlrev_b32 v1, 9, v1
    v_and_b32 v2, 15, v0
    v_lshl_add_u32 v1, v2, 5, v1
    v_bfe_u32 v2, v0, 4, 1
    v_lshl_add_u32 v1, v2, 4, v1
    s_lshl_b32 s63, s34, 10
    s_add_u32 s63, s63, 65536
    v_add_u32 v1, s63, v1
    s_getreg_b32 s63, hwreg(HW_REG_XCC_ID)
    s_and_b32 s63, s63, 0xff
    s_lshl_b32 s63, s63, 8
    v_mov_b32 v16, s63
    v_mov_b32 v17, s63
    v_mov_b32 v18, s63
    v_mov_b32 v19, s63
    v_and_or_b32 v16, v16, v12, s57
    v_and_or_b32 v17, v17, v12, s58
    v_and_or_b32 v18, v18, v12, s59
    v_and_or_b32 v19, v19, v12, s60
    s_lshl_b32 s63, s34, 4
    s_add_u32 s63, s63, 327680
    v_mov_b32 v2, s63
    s_mov_b64 exec, 1
    buffer_store_dwordx4 v[16:19], v2, s[44:47], 0 offen
    s_mov_b64 exec, -1
    s_waitcnt lgkmcnt(0)
    s_nop 0
    v_lshl_or_b32 v32, v32, 16, v32
    v_lshl_or_b32 v33, v33, 16, v33
    v_lshl_or_b32 v34, v34, 16, v34
    v_lshl_or_b32 v35, v35, 16, v35
    v_lshl_or_b32 v36, v36, 16, v36
    v_lshl_or_b32 v37, v37, 16, v37
    v_lshl_or_b32 v38, v38, 16, v38
    v_lshl_or_b32 v39, v39, 16, v39
    v_lshl_or_b32 v40, v40, 16, v40
    v_lshl_or_b32 v41, v41, 16, v41
    v_lshl_or_b32 v42, v42, 16, v42
    v_lshl_or_b32 v43, v43, 16, v43
    v_lshl_or_b32 v44, v44, 16, v44
    v_lshl_or_b32 v45, v45, 16, v45
    v_lshl_or_b32 v46, v46, 16, v46
    v_lshl_or_b32 v47, v47, 16, v47
    v_lshl_or_b32 v48, v48, 16, v48
    v_lshl_or_b32 v49, v49, 16, v49
    v_and_b32 v52, v32, v8
    v_and_b32 v53, v32, v9
    v_and_b32 v54, v32, v10
    v_and_b32 v55, v32, v11
    s_waitcnt vmcnt(18)
    s_nop 0
    v_mfma_f32_16x16x32_bf16 v[4:7], v[52:55], a[0:3], 0
    v_and_b32 v56, v33, v8
    v_and_b32 v57, v33, v9
    v_and_b32 v58, v33, v10
    v_and_b32 v59, v33, v11
    s_waitcnt vmcnt(17)
    s_nop 0
    v_mfma_f32_16x16x32_bf16 v[4:7], v[56:59], a[4:7], v[4:7]
    v_and_b32 v52, v34, v8
    v_and_b32 v53, v34, v9
    v_and_b32 v54, v34, v10
    v_and_b32 v55, v34, v11
    s_waitcnt vmcnt(16)
    s_nop 0
    v_mfma_f32_16x16x32_bf16 v[4:7], v[52:55], a[8:11], v[4:7]
    v_and_b32 v56, v35, v8
    v_and_b32 v57, v35, v9
    v_and_b32 v58, v35, v10
    v_and_b32 v59, v35, v11
    s_waitcnt vmcnt(15)
    s_nop 0
    v_mfma_f32_16x16x32_bf16 v[4:7], v[56:59], a[12:15], v[4:7]
    v_and_b32 v52, v36, v8
    v_and_b32 v53, v36, v9
    v_and_b32 v54, v36, v10
    v_and_b32 v55, v36, v11
    s_waitcnt vmcnt(14)
    s_nop 0
    v_mfma_f32_16x16x32_bf16 v[4:7], v[52:55], a[16:19], v[4:7]
    v_and_b32 v56, v37, v8
    v_and_b32 v57, v37, v9
    v_and_b32 v58, v37, v10
    v_and_b32 v59, v37, v11
    s_waitcnt vmcnt(13)
    s_nop 0
    v_mfma_f32_16x16x32_bf16 v[4:7], v[56:59], a[20:23], v[4:7]
    v_and_b32 v52, v38, v8
    v_and_b32 v53, v38, v9
    v_and_b32 v54, v38, v10
    v_and_b32 v55, v38, v11
    s_waitcnt vmcnt(12)
    s_nop 0
    v_mfma_f32_16x16x32_bf16 v[4:7], v[52:55], a[24:27], v[4:7]
    v_and_b32 v56, v39, v8
    v_and_b32 v57, v39, v9
    v_and_b32 v58, v39, v10
    v_and_b32 v59, v39, v11
    s_waitcnt vmcnt(11)
    s_nop 0
    v_mfma_f32_16x16x32_bf16 v[4:7], v[56:59], a[28:31], v[4:7]
    v_and_b32 v52, v40, v8
    v_and_b32 v53, v40, v9
    v_and_b32 v54, v40, v10
    v_and_b32 v55, v40, v11
    s_waitcnt vmcnt(10)
    s_nop 0
    v_mfma_f32_16x16x32_bf16 v[4:7], v[52:55], a[32:35], v[4:7]
    v_and_b32 v56, v41, v8
    v_and_b32 v57, v41, v9
    v_and_b32 v58, v41, v10
    v_and_b32 v59, v41, v11
    s_waitcnt vmcnt(9)
    s_nop 0
    v_mfma_f32_16x16x32_bf16 v[4:7], v[56:59], a[36:39], v[4:7]
    v_and_b32 v52, v42, v8
    v_and_b32 v53, v42, v9
    v_and_b32 v54, v42, v10
    v_and_b32 v55, v42, v11
    s_waitcnt vmcnt(8)
    s_nop 0
    v_mfma_f32_16x16x32_bf16 v[4:7], v[52:55], a[40:43], v[4:7]
    v_and_b32 v56, v43, v8
    v_and_b32 v57, v43, v9
    v_and_b32 v58, v43, v10
    v_and_b32 v59, v43, v11
    s_waitcnt vmcnt(7)
    s_nop 0
    v_mfma_f32_16x16x32_bf16 v[4:7], v[56:59], a[44:47], v[4:7]
    v_and_b32 v52, v44, v8
    v_and_b32 v53, v44, v9
    v_and_b32 v54, v44, v10
    v_and_b32 v55, v44, v11
    s_waitcnt vmcnt(6)
    s_nop 0
    v_mfma_f32_16x16x32_bf16 v[4:7], v[52:55], a[48:51], v[4:7]
    v_and_b32 v56, v45, v8
    v_and_b32 v57, v45, v9
    v_and_b32 v58, v45, v10
    v_and_b32 v59, v45, v11
    s_waitcnt vmcnt(5)
    s_nop 0
    v_mfma_f32_16x16x32_bf16 v[4:7], v[56:59], a[52:55], v[4:7]
    v_and_b32 v52, v46, v8
    v_and_b32 v53, v46, v9
    v_and_b32 v54, v46, v10
    v_and_b32 v55, v46, v11
    s_waitcnt vmcnt(4)
    s_nop 0
    v_mfma_f32_16x16x32_bf16 v[4:7], v[52:55], a[56:59], v[4:7]
    v_and_b32 v56, v47, v8
    v_and_b32 v57, v47, v9
    v_and_b32 v58, v47, v10
    v_and_b32 v59, v47, v11
    s_waitcnt vmcnt(3)
    s_nop 0
    v_mfma_f32_16x16x32_bf16 v[4:7], v[56:59], a[60:63], v[4:7]
    v_and_b32 v52, v48, v8
    v_and_b32 v53, v48, v9
    v_and_b32 v54, v48, v10
    v_and_b32 v55, v48, v11
    s_waitcnt vmcnt(2)
    s_nop 0
    v_mfma_f32_16x16x32_bf16 v[4:7], v[52:55], a[64:67], v[4:7]
    v_and_b32 v56, v49, v8
    v_and_b32 v57, v49, v9
    v_and_b32 v58, v49, v10
    v_and_b32 v59, v49, v11
    s_waitcnt vmcnt(1)
    s_nop 0
    v_mfma_f32_16x16x32_bf16 v[4:7], v[56:59], a[68:71], v[4:7]
    s_nop 7
    v_and_or_b32 v4, v4, v12, s57
    v_and_or_b32 v5, v5, v12, s58
    v_and_or_b32 v6, v6, v12, s59
    v_and_or_b32 v7, v7, v12, s60
    buffer_store_dwordx4 v[4:7], v1, s[44:47], 0 offen
    v_mov_b32 v2, 0
    v_mov_b32 v3, 2
    ds_write_b32 v2, v3 offset:36
    s_sub_u32 s64, s3, 1
    s_max_i32 s64, s64, 0
    s_mul_i32 s63, s64, 2816
    v_lshlrev_b32 v1, 4, v0
    v_add_u32 v1, s63, v1
    s_add_u32 s63, s63, 2048
    v_mul_u32_u24 v2, 12, v0
    v_add_u32 v2, s63, v2
    s_mov_b32 s48, s16
    s_and_b32 s49, s17, 0xffff
    s_mov_b32 s50, 9216
    s_mov_b32 s51, 0x20000
    buffer_load_dwordx4 v[92:95], v1, s[48:51], 0 offen
    buffer_load_dwordx4 v[96:99], v1, s[48:51], 0 offen offset:1024
    buffer_load_dwordx3 v[100:102], v2, s[48:51], 0 offen
    s_mov_b32 s48, s18
    s_nop 0
    s_and_b32 s49, s19, 0xffff
    s_mov_b32 s50, 9216
    s_mov_b32 s51, 0x20000
    buffer_load_dwordx4 v[104:107], v1, s[48:51], 0 offen
    buffer_load_dwordx4 v[108:111], v1, s[48:51], 0 offen offset:1024
    buffer_load_dwordx3 v[112:114], v2, s[48:51], 0 offen
    s_mov_b32 s48, s20
    s_nop 0
    s_and_b32 s49, s21, 0xffff
    s_mov_b32 s50, 9216
    s_mov_b32 s51, 0x20000
    buffer_load_dwordx4 v[116:119], v1, s[48:51], 0 offen
    buffer_load_dwordx4 v[120:123], v1, s[48:51], 0 offen offset:1024
    buffer_load_dwordx3 v[124:126], v2, s[48:51], 0 offen
    s_waitcnt vmcnt(0)
    s_branch L_table
L_stream2:
    s_mov_b32 s44, s28
    s_and_b32 s45, s29, 0xffff
    s_mov_b32 s46, 4194304
    s_mov_b32 s47, 0x20000
    v_and_b32 v19, 1, v0
    v_lshlrev_b32 v19, 4, v19
    v_mov_b32 v20, 0xffff
    v_lshlrev_b32 v19, v19, v20
    v_bfe_u32 v20, v0, 1, 2
    v_cmp_eq_u32 vcc, 0, v20
    s_nop 1
    v_cndmask_b32 v8, 0, v19, vcc
    v_cmp_eq_u32 vcc, 1, v20
    s_nop 1
    v_cndmask_b32 v9, 0, v19, vcc
    v_cmp_eq_u32 vcc, 2, v20
    s_nop 1
    v_cndmask_b32 v10, 0, v19, vcc
    v_cmp_eq_u32 vcc, 3, v20
    s_nop 1
    v_cndmask_b32 v11, 0, v19, vcc
    v_mov_b32 v12, 0
    v_mov_b32 v13, 0
    v_mov_b32 v14, 0
    v_mov_b32 v15, 0
    v_mov_b32 v16, 0xff7fffff
    v_mov_b32 v17, 0
    v_lshrrev_b32 v21, 4, v0
    v_lshlrev_b32 v21, 6, v21
    v_and_b32 v20, 3, v0
    v_lshl_add_u32 v21, v20, 4, v21
    v_bfe_u32 v20, v0, 3, 1
    v_lshl_add_u32 v21, v20, 8, v21
    s_mov_b32 s92, 0x3db504f3
    s_waitcnt vmcnt(6)
    buffer_load_dwordx4 a[28:31], v1, s[36:39], s66 offen nt
    s_add_u32 s66, s66, s68
    s_waitcnt vmcnt(6)
    buffer_load_dwordx4 a[32:35], v1, s[36:39], s66 offen nt
    s_add_u32 s66, s66, s68
    s_waitcnt vmcnt(6)
    buffer_load_dwordx4 a[36:39], v1, s[36:39], s66 offen nt
    s_add_u32 s66, s66, s68
    s_waitcnt vmcnt(6)
    buffer_load_dwordx4 a[40:43], v1, s[36:39], s66 offen nt
    s_add_u32 s66, s66, s68
    s_waitcnt vmcnt(6)
    buffer_load_dwordx4 a[44:47], v1, s[36:39], s66 offen nt
    s_add_u32 s66, s66, s68
    s_waitcnt vmcnt(6)
    buffer_load_dwordx4 a[48:51], v1, s[36:39], s66 offen nt
    s_add_u32 s66, s66, s68
    s_waitcnt vmcnt(6)
    buffer_load_dwordx4 a[52:55], v1, s[36:39], s66 offen nt
    s_add_u32 s66, s66, s68
    s_waitcnt vmcnt(6)
    buffer_load_dwordx4 a[56:59], v1, s[36:39], s66 offen nt
    s_add_u32 s66, s66, s68
    s_waitcnt vmcnt(6)
    buffer_load_dwordx4 a[60:63], v1, s[36:39], s66 offen nt
    s_add_u32 s66, s66, s68
    s_waitcnt vmcnt(6)
    buffer_load_dwordx4 a[64:67], v1, s[36:39], s66 offen nt
    s_add_u32 s66, s66, s68
    s_waitcnt vmcnt(6)
    buffer_load_dwordx4 a[68:71], v1, s[36:39], s66 offen nt
    s_add_u32 s66, s66, s68
    s_waitcnt vmcnt(6)
    buffer_load_dwordx4 a[72:75], v1, s[36:39], s66 offen nt
    s_add_u32 s66, s66, s68
    s_waitcnt vmcnt(6)
    buffer_load_dwordx4 a[76:79], v1, s[36:39], s66 offen nt
    s_add_u32 s66, s66, s68
    s_waitcnt vmcnt(6)
    buffer_load_dwordx4 a[80:83], v1, s[36:39], s66 offen nt
    s_add_u32 s66, s66, s68
    s_waitcnt vmcnt(6)
    buffer_load_dwordx4 a[84:87], v1, s[36:39], s66 offen nt
    s_add_u32 s66, s66, s68
    s_waitcnt vmcnt(6)
    buffer_load_dwordx4 a[88:91], v1, s[36:39], s66 offen nt
    s_add_u32 s66, s66, s68
    s_waitcnt vmcnt(6)
    buffer_load_dwordx4 a[92:95], v1, s[36:39], s66 offen nt
    s_add_u32 s66, s66, s68
    s_waitcnt vmcnt(6)
    buffer_load_dwordx4 a[96:99], v1, s[36:39], s66 offen nt
    s_add_u32 s66, s66, s68
    s_waitcnt vmcnt(6)
    buffer_load_dwordx4 a[100:103], v1, s[36:39], s66 offen nt
    s_add_u32 s66, s66, s68
    s_waitcnt vmcnt(6)
    buffer_load_dwordx4 a[104:107], v1, s[36:39], s66 offen nt
    s_add_u32 s66, s66, s68
    s_waitcnt vmcnt(6)
    buffer_load_dwordx4 a[108:111], v1, s[36:39], s66 offen nt
    s_add_u32 s66, s66, s68
    s_waitcnt vmcnt(6)
    buffer_load_dwordx4 a[112:115], v1, s[36:39], s66 offen nt
    s_add_u32 s66, s66, s68
    s_waitcnt vmcnt(6)
    buffer_load_dwordx4 a[116:119], v1, s[36:39], s66 offen nt
    s_add_u32 s66, s66, s68
    s_waitcnt vmcnt(6)
    buffer_load_dwordx4 a[120:123], v1, s[36:39], s66 offen nt
    s_add_u32 s66, s66, s68
    s_waitcnt vmcnt(6)
    buffer_load_dwordx4 a[124:127], v1, s[36:39], s66 offen nt
    s_add_u32 s66, s66, s68
    s_waitcnt vmcnt(6)
    buffer_load_dwordx4 v[96:99], v2, s[40:43], s67 offen nt
    s_add_u32 s67, s67, s68
    s_waitcnt vmcnt(6)
    buffer_load_dwordx4 v[100:103], v2, s[40:43], s67 offen nt
    s_add_u32 s67, s67, s68
    s_waitcnt vmcnt(6)
    buffer_load_dwordx4 v[104:107], v2, s[40:43], s67 offen nt
    s_add_u32 s67, s67, s68
    s_waitcnt vmcnt(6)
    buffer_load_dwordx4 v[108:111], v2, s[40:43], s67 offen nt
    s_add_u32 s67, s67, s68
    s_waitcnt vmcnt(6)
    buffer_load_dwordx4 v[112:115], v2, s[40:43], s67 offen nt
    s_add_u32 s67, s67, s68
    s_waitcnt vmcnt(6)
    buffer_load_dwordx4 v[116:119], v2, s[40:43], s67 offen nt
    s_add_u32 s67, s67, s68
    s_waitcnt vmcnt(6)
    buffer_load_dwordx4 v[120:123], v2, s[40:43], s67 offen nt
    s_add_u32 s67, s67, s68
    s_waitcnt vmcnt(6)
    buffer_load_dwordx4 v[124:127], v2, s[40:43], s67 offen nt
    s_add_u32 s67, s67, s68
    s_mov_b32 s65, 0
    v_mov_b32 v20, 0
L_lw1:
    ds_read_b32 v19, v20 offset:0
    s_waitcnt lgkmcnt(0)
    v_readfirstlane_b32 s63, v19
    s_cmp_ge_u32 s63, 1
    s_cbranch_scc1 L_lwd2
    s_add_u32 s65, s65, 1
    s_cmp_gt_u32 s65, 400000
    s_cbranch_scc1 L_end
    s_sleep 1
    s_branch L_lw1
L_lwd2:
    ds_read_b128 v[4:7], v21 offset:64
    ds_read_b64 v[22:23], v20 offset:24
    s_waitcnt lgkmcnt(0)
    v_readfirstlane_b32 s69, v22
    v_readfirstlane_b32 s56, v23
    s_waitcnt vmcnt(39)
    v_mfma_f32_16x16x32_bf16 v[32:35], a[0:3], v[4:7], 0
    s_waitcnt vmcnt(38)
    v_mfma_f32_16x16x32_bf16 v[36:39], a[4:7], v[4:7], 0
    s_waitcnt vmcnt(6)
    buffer_load_dwordx4 a[0:3], v1, s[36:39], s66 offen nt
    s_add_u32 s66, s66, s68
    s_waitcnt vmcnt(38)
    v_mfma_f32_16x16x32_bf16 v[40:43], a[8:11], v[4:7], 0
    s_waitcnt vmcnt(37)
    v_mfma_f32_16x16x32_bf16 v[44:47], a[12:15], v[4:7], 0
    s_waitcnt vmcnt(6)
    buffer_load_dwordx4 a[4:7], v1, s[36:39], s66 offen nt
    s_add_u32 s66, s66, s68
    s_waitcnt vmcnt(37)
    v_mfma_f32_16x16x32_bf16 v[48:51], a[16:19], v[4:7], 0
    s_waitcnt vmcnt(36)
    v_mfma_f32_16x16x32_bf16 v[52:55], a[20:23], v[4:7], 0
    s_waitcnt vmcnt(35)
    v_mfma_f32_16x16x32_bf16 v[56:59], a[24:27], v[4:7], 0
    s_waitcnt vmcnt(34)
    s_nop 0
    v_mfma_f32_16x16x32_bf16 v[60:63], a[28:31], v[4:7], 0
    v_add_f32_dpp v32, v33, v32 quad_perm:[1,1,1,1] row_mask:0xf bank_mask:0xf
    v_add_f32_dpp v36, v37, v36 quad_perm:[1,1,1,1] row_mask:0xf bank_mask:0xf
    v_add_f32_dpp v40, v41, v40 quad_perm:[1,1,1,1] row_mask:0xf bank_mask:0xf
    v_add_f32_dpp v44, v45, v44 quad_perm:[1,1,1,1] row_mask:0xf bank_mask:0xf
    v_add_f32_dpp v48, v49, v48 quad_perm:[1,1,1,1] row_mask:0xf bank_mask:0xf
    v_add_f32_dpp v52, v53, v52 quad_perm:[1,1,1,1] row_mask:0xf bank_mask:0xf
    v_add_f32_dpp v56, v57, v56 quad_perm:[1,1,1,1] row_mask:0xf bank_mask:0xf
    s_nop 0
    s_nop 0
    v_add_f32_dpp v60, v61, v60 quad_perm:[1,1,1,1] row_mask:0xf bank_mask:0xf
    v_add_f32_dpp v32, v34, v32 quad_perm:[2,2,2,2] row_mask:0xf bank_mask:0xf
    v_add_f32_dpp v36, v38, v36 quad_perm:[2,2,2,2] row_mask:0xf bank_mask:0xf
    v_add_f32_dpp v40, v42, v40 quad_perm:[2,2,2,2] row_mask:0xf bank_mask:0xf
    v_add_f32_dpp v44, v46, v44 quad_perm:[2,2,2,2] row_mask:0xf bank_mask:0xf
    v_add_f32_dpp v48, v50, v48 quad_perm:[2,2,2,2] row_mask:0xf bank_mask:0xf
    v_add_f32_dpp v52, v54, v52 quad_perm:[2,2,2,2] row_mask:0xf bank_mask:0xf
    v_add_f32_dpp v56, v58, v56 quad_perm:[2,2,2,2] row_mask:0xf bank_mask:0xf
    v_add_f32_dpp v60, v62, v60 quad_perm:[2,2,2,2] row_mask:0xf bank_mask:0xf
    v_add_f32_dpp v64, v35, v32 quad_perm:[3,3,3,3] row_mask:0xf bank_mask:0xf
    v_add_f32_dpp v65, v39, v36 quad_perm:[3,3,3,3] row_mask:0xf bank_mask:0xf
    v_add_f32_dpp v66, v43, v40 quad_perm:[3,3,3,3] row_mask:0xf bank_mask:0xf
    v_add_f32_dpp v67, v47, v44 quad_perm:[3,3,3,3] row_mask:0xf bank_mask:0xf
    v_add_f32_dpp v68, v51, v48 quad_perm:[3,3,3,3] row_mask:0xf bank_mask:0xf
    v_add_f32_dpp v69, v55, v52 quad_perm:[3,3,3,3] row_mask:0xf bank_mask:0xf
    v_add_f32_dpp v70, v59, v56 quad_perm:[3,3,3,3] row_mask:0xf bank_mask:0xf
    v_add_f32_dpp v71, v63, v60 quad_perm:[3,3,3,3] row_mask:0xf bank_mask:0xf
    s_waitcnt vmcnt(6)
    buffer_load_dwordx4 a[8:11], v1, s[36:39], s66 offen nt
    s_add_u32 s66, s66, s68
    v_cvt_pk_bf16_f32 v32, v64, v65
    v_cvt_pk_bf16_f32 v34, v66, v67
    v_cvt_pk_bf16_f32 v36, v68, v69
    v_cvt_pk_bf16_f32 v38, v70, v71
    v_and_b32 v65, 0xffff0000, v32
    v_lshlrev_b32 v64, 16, v32
    v_and_b32 v67, 0xffff0000, v34
    v_lshlrev_b32 v66, 16, v34
    v_and_b32 v69, 0xffff0000, v36
    v_lshlrev_b32 v68, 16, v36
    v_and_b32 v71, 0xffff0000, v38
    v_lshlrev_b32 v70, 16, v38
    v_pk_mul_f32 v[64:65], v[64:65], s[92:93] op_sel_hi:[1,0]
    v_pk_mul_f32 v[66:67], v[66:67], s[92:93] op_sel_hi:[1,0]
    v_pk_mul_f32 v[68:69], v[68:69], s[92:93] op_sel_hi:[1,0]
    v_pk_mul_f32 v[70:71], v[70:71], s[92:93] op_sel_hi:[1,0]
    v_cvt_pk_bf16_f32 v32, v64, v65
    v_cvt_pk_bf16_f32 v34, v66, v67
    v_cvt_pk_bf16_f32 v36, v68, v69
    v_cvt_pk_bf16_f32 v38, v70, v71
    v_and_b32 v65, 0xffff0000, v32
    v_lshlrev_b32 v64, 16, v32
    v_and_b32 v67, 0xffff0000, v34
    v_lshlrev_b32 v66, 16, v34
    v_and_b32 v69, 0xffff0000, v36
    v_lshlrev_b32 v68, 16, v36
    v_and_b32 v71, 0xffff0000, v38
    v_lshlrev_b32 v70, 16, v38
    v_max3_f32 v19, v64, v65, v66
    v_max3_f32 v20, v67, v68, v69
    v_max3_f32 v19, v19, v70, v71
    v_max3_f32 v19, v19, v20, v16
    s_waitcnt vmcnt(6)
    buffer_load_dwordx4 a[12:15], v1, s[36:39], s66 offen nt
    s_add_u32 s66, s66, s68
    v_mov_b32_dpp v19, v19 quad_perm:[0,0,0,0] row_mask:0xf bank_mask:0xf
    v_mov_b32 v20, v19
    s_nop 1
    v_permlane16_swap_b32 v19, v20
    v_max_f32 v19, v19, v20
    v_mov_b32 v20, v19
    s_nop 1
    v_permlane32_swap_b32 v19, v20
    v_max_f32 v19, v19, v20
    v_mov_b32 v16, v19
    s_waitcnt vmcnt(35)
    v_mfma_f32_16x16x32_bf16 v[32:35], a[32:35], v[4:7], 0
    s_waitcnt vmcnt(34)
    v_mfma_f32_16x16x32_bf16 v[36:39], a[36:39], v[4:7], 0
    s_waitcnt vmcnt(6)
    buffer_load_dwordx4 a[16:19], v1, s[36:39], s66 offen nt
    s_add_u32 s66, s66, s68
    s_waitcnt vmcnt(34)
    v_mfma_f32_16x16x32_bf16 v[40:43], a[40:43], v[4:7], 0
    s_waitcnt vmcnt(33)
    v_mfma_f32_16x16x32_bf16 v[44:47], a[44:47], v[4:7], 0
    s_waitcnt vmcnt(6)
    buffer_load_dwordx4 a[20:23], v1, s[36:39], s66 offen nt
    s_add_u32 s66, s66, s68
    s_waitcnt vmcnt(33)
    v_mfma_f32_16x16x32_bf16 v[48:51], a[48:51], v[4:7], 0
    s_waitcnt vmcnt(32)
    v_mfma_f32_16x16x32_bf16 v[52:55], a[52:55], v[4:7], 0
    s_waitcnt vmcnt(31)
    v_mfma_f32_16x16x32_bf16 v[56:59], a[56:59], v[4:7], 0
    s_waitcnt vmcnt(30)
    s_nop 0
    v_mfma_f32_16x16x32_bf16 v[60:63], a[60:63], v[4:7], 0
    v_add_f32_dpp v32, v33, v32 quad_perm:[1,1,1,1] row_mask:0xf bank_mask:0xf
    v_add_f32_dpp v36, v37, v36 quad_perm:[1,1,1,1] row_mask:0xf bank_mask:0xf
    v_add_f32_dpp v40, v41, v40 quad_perm:[1,1,1,1] row_mask:0xf bank_mask:0xf
    v_add_f32_dpp v44, v45, v44 quad_perm:[1,1,1,1] row_mask:0xf bank_mask:0xf
    v_add_f32_dpp v48, v49, v48 quad_perm:[1,1,1,1] row_mask:0xf bank_mask:0xf
    v_add_f32_dpp v52, v53, v52 quad_perm:[1,1,1,1] row_mask:0xf bank_mask:0xf
    v_add_f32_dpp v56, v57, v56 quad_perm:[1,1,1,1] row_mask:0xf bank_mask:0xf
    s_nop 0
    s_nop 0
    v_add_f32_dpp v60, v61, v60 quad_perm:[1,1,1,1] row_mask:0xf bank_mask:0xf
    v_add_f32_dpp v32, v34, v32 quad_perm:[2,2,2,2] row_mask:0xf bank_mask:0xf
    v_add_f32_dpp v36, v38, v36 quad_perm:[2,2,2,2] row_mask:0xf bank_mask:0xf
    v_add_f32_dpp v40, v42, v40 quad_perm:[2,2,2,2] row_mask:0xf bank_mask:0xf
    v_add_f32_dpp v44, v46, v44 quad_perm:[2,2,2,2] row_mask:0xf bank_mask:0xf
    v_add_f32_dpp v48, v50, v48 quad_perm:[2,2,2,2] row_mask:0xf bank_mask:0xf
    v_add_f32_dpp v52, v54, v52 quad_perm:[2,2,2,2] row_mask:0xf bank_mask:0xf
    v_add_f32_dpp v56, v58, v56 quad_perm:[2,2,2,2] row_mask:0xf bank_mask:0xf
    v_add_f32_dpp v60, v62, v60 quad_perm:[2,2,2,2] row_mask:0xf bank_mask:0xf
    v_add_f32_dpp v72, v35, v32 quad_perm:[3,3,3,3] row_mask:0xf bank_mask:0xf
    v_add_f32_dpp v73, v39, v36 quad_perm:[3,3,3,3] row_mask:0xf bank_mask:0xf
    v_add_f32_dpp v74, v43, v40 quad_perm:[3,3,3,3] row_mask:0xf bank_mask:0xf
    v_add_f32_dpp v75, v47, v44 quad_perm:[3,3,3,3] row_mask:0xf bank_mask:0xf
    v_add_f32_dpp v76, v51, v48 quad_perm:[3,3,3,3] row_mask:0xf bank_mask:0xf
    v_add_f32_dpp v77, v55, v52 quad_perm:[3,3,3,3] row_mask:0xf bank_mask:0xf
    v_add_f32_dpp v78, v59, v56 quad_perm:[3,3,3,3] row_mask:0xf bank_mask:0xf
    v_add_f32_dpp v79, v63, v60 quad_perm:[3,3,3,3] row_mask:0xf bank_mask:0xf
    s_waitcnt vmcnt(6)
    buffer_load_dwordx4 a[24:27], v1, s[36:39], s66 offen nt
    s_add_u32 s66, s66, s68
    v_cvt_pk_bf16_f32 v32, v72, v73
    v_cvt_pk_bf16_f32 v34, v74, v75
    v_cvt_pk_bf16_f32 v36, v76, v77
    v_cvt_pk_bf16_f32 v38, v78, v79
    v_and_b32 v73, 0xffff0000, v32
    v_lshlrev_b32 v72, 16, v32
    v_and_b32 v75, 0xffff0000, v34
    v_lshlrev_b32 v74, 16, v34
    v_and_b32 v77, 0xffff0000, v36
    v_lshlrev_b32 v76, 16, v36
    v_and_b32 v79, 0xffff0000, v38
    v_lshlrev_b32 v78, 16, v38
    v_pk_mul_f32 v[72:73], v[72:73], s[92:93] op_sel_hi:[1,0]
    v_pk_mul_f32 v[74:75], v[74:75], s[92:93] op_sel_hi:[1,0]
    v_pk_mul_f32 v[76:77], v[76:77], s[92:93] op_sel_hi:[1,0]
    v_pk_mul_f32 v[78:79], v[78:79], s[92:93] op_sel_hi:[1,0]
    v_cvt_pk_bf16_f32 v32, v72, v73
    v_cvt_pk_bf16_f32 v34, v74, v75
    v_cvt_pk_bf16_f32 v36, v76, v77
    v_cvt_pk_bf16_f32 v38, v78, v79
    v_and_b32 v73, 0xffff0000, v32
    v_lshlrev_b32 v72, 16, v32
    v_and_b32 v75, 0xffff0000, v34
    v_lshlrev_b32 v74, 16, v34
    v_and_b32 v77, 0xffff0000, v36
    v_lshlrev_b32 v76, 16, v36
    v_and_b32 v79, 0xffff0000, v38
    v_lshlrev_b32 v78, 16, v38
    v_max3_f32 v19, v72, v73, v74
    v_max3_f32 v20, v75, v76, v77
    v_max3_f32 v19, v19, v78, v79
    v_max3_f32 v19, v19, v20, v16
    s_waitcnt vmcnt(6)
    buffer_load_dwordx4 a[28:31], v1, s[36:39], s66 offen nt
    s_add_u32 s66, s66, s68
    v_mov_b32_dpp v19, v19 quad_perm:[0,0,0,0] row_mask:0xf bank_mask:0xf
    v_mov_b32 v20, v19
    s_nop 1
    v_permlane16_swap_b32 v19, v20
    v_max_f32 v19, v19, v20
    v_mov_b32 v20, v19
    s_nop 1
    v_permlane32_swap_b32 v19, v20
    v_max_f32 v19, v19, v20
    v_mov_b32 v16, v19
    s_waitcnt vmcnt(31)
    v_mfma_f32_16x16x32_bf16 v[32:35], a[64:67], v[4:7], 0
    s_waitcnt vmcnt(30)
    v_mfma_f32_16x16x32_bf16 v[36:39], a[68:71], v[4:7], 0
    s_waitcnt vmcnt(6)
    buffer_load_dwordx4 a[32:35], v2, s[40:43], s67 offen nt
    s_add_u32 s67, s67, s68
    s_waitcnt vmcnt(30)
    v_mfma_f32_16x16x32_bf16 v[40:43], a[72:75], v[4:7], 0
    s_waitcnt vmcnt(29)
    v_mfma_f32_16x16x32_bf16 v[44:47], a[76:79], v[4:7], 0
    s_waitcnt vmcnt(6)
    buffer_load_dwordx4 a[36:39], v2, s[40:43], s67 offen nt
    s_add_u32 s67, s67, s68
    s_waitcnt vmcnt(29)
    v_mfma_f32_16x16x32_bf16 v[48:51], a[80:83], v[4:7], 0
    s_waitcnt vmcnt(28)
    v_mfma_f32_16x16x32_bf16 v[52:55], a[84:87], v[4:7], 0
    s_waitcnt vmcnt(27)
    v_mfma_f32_16x16x32_bf16 v[56:59], a[88:91], v[4:7], 0
    s_waitcnt vmcnt(26)
    s_nop 0
    v_mfma_f32_16x16x32_bf16 v[60:63], a[92:95], v[4:7], 0
    v_add_f32_dpp v32, v33, v32 quad_perm:[1,1,1,1] row_mask:0xf bank_mask:0xf
    v_add_f32_dpp v36, v37, v36 quad_perm:[1,1,1,1] row_mask:0xf bank_mask:0xf
    v_add_f32_dpp v40, v41, v40 quad_perm:[1,1,1,1] row_mask:0xf bank_mask:0xf
    v_add_f32_dpp v44, v45, v44 quad_perm:[1,1,1,1] row_mask:0xf bank_mask:0xf
    v_add_f32_dpp v48, v49, v48 quad_perm:[1,1,1,1] row_mask:0xf bank_mask:0xf
    v_add_f32_dpp v52, v53, v52 quad_perm:[1,1,1,1] row_mask:0xf bank_mask:0xf
    v_add_f32_dpp v56, v57, v56 quad_perm:[1,1,1,1] row_mask:0xf bank_mask:0xf
    s_nop 0
    s_nop 0
    v_add_f32_dpp v60, v61, v60 quad_perm:[1,1,1,1] row_mask:0xf bank_mask:0xf
    v_add_f32_dpp v32, v34, v32 quad_perm:[2,2,2,2] row_mask:0xf bank_mask:0xf
    v_add_f32_dpp v36, v38, v36 quad_perm:[2,2,2,2] row_mask:0xf bank_mask:0xf
    v_add_f32_dpp v40, v42, v40 quad_perm:[2,2,2,2] row_mask:0xf bank_mask:0xf
    v_add_f32_dpp v44, v46, v44 quad_perm:[2,2,2,2] row_mask:0xf bank_mask:0xf
    v_add_f32_dpp v48, v50, v48 quad_perm:[2,2,2,2] row_mask:0xf bank_mask:0xf
    v_add_f32_dpp v52, v54, v52 quad_perm:[2,2,2,2] row_mask:0xf bank_mask:0xf
    v_add_f32_dpp v56, v58, v56 quad_perm:[2,2,2,2] row_mask:0xf bank_mask:0xf
    v_add_f32_dpp v60, v62, v60 quad_perm:[2,2,2,2] row_mask:0xf bank_mask:0xf
    v_add_f32_dpp v80, v35, v32 quad_perm:[3,3,3,3] row_mask:0xf bank_mask:0xf
    v_add_f32_dpp v81, v39, v36 quad_perm:[3,3,3,3] row_mask:0xf bank_mask:0xf
    v_add_f32_dpp v82, v43, v40 quad_perm:[3,3,3,3] row_mask:0xf bank_mask:0xf
    v_add_f32_dpp v83, v47, v44 quad_perm:[3,3,3,3] row_mask:0xf bank_mask:0xf
    v_add_f32_dpp v84, v51, v48 quad_perm:[3,3,3,3] row_mask:0xf bank_mask:0xf
    v_add_f32_dpp v85, v55, v52 quad_perm:[3,3,3,3] row_mask:0xf bank_mask:0xf
    v_add_f32_dpp v86, v59, v56 quad_perm:[3,3,3,3] row_mask:0xf bank_mask:0xf
    v_add_f32_dpp v87, v63, v60 quad_perm:[3,3,3,3] row_mask:0xf bank_mask:0xf
    s_waitcnt vmcnt(6)
    buffer_load_dwordx4 a[40:43], v2, s[40:43], s67 offen nt
    s_add_u32 s67, s67, s68
    v_cvt_pk_bf16_f32 v32, v80, v81
    v_cvt_pk_bf16_f32 v34, v82, v83
    v_cvt_pk_bf16_f32 v36, v84, v85
    v_cvt_pk_bf16_f32 v38, v86, v87
    v_and_b32 v81, 0xffff0000, v32
    v_lshlrev_b32 v80, 16, v32
    v_and_b32 v83, 0xffff0000, v34
    v_lshlrev_b32 v82, 16, v34
    v_and_b32 v85, 0xffff0000, v36
    v_lshlrev_b32 v84, 16, v36
    v_and_b32 v87, 0xffff0000, v38
    v_lshlrev_b32 v86, 16, v38
    v_pk_mul_f32 v[80:81], v[80:81], s[92:93] op_sel_hi:[1,0]
    v_pk_mul_f32 v[82:83], v[82:83], s[92:93] op_sel_hi:[1,0]
    v_pk_mul_f32 v[84:85], v[84:85], s[92:93] op_sel_hi:[1,0]
    v_pk_mul_f32 v[86:87], v[86:87], s[92:93] op_sel_hi:[1,0]
    v_cvt_pk_bf16_f32 v32, v80, v81
    v_cvt_pk_bf16_f32 v34, v82, v83
    v_cvt_pk_bf16_f32 v36, v84, v85
    v_cvt_pk_bf16_f32 v38, v86, v87
    v_and_b32 v81, 0xffff0000, v32
    v_lshlrev_b32 v80, 16, v32
    v_and_b32 v83, 0xffff0000, v34
    v_lshlrev_b32 v82, 16, v34
    v_and_b32 v85, 0xffff0000, v36
    v_lshlrev_b32 v84, 16, v36
    v_and_b32 v87, 0xffff0000, v38
    v_lshlrev_b32 v86, 16, v38
    v_max3_f32 v19, v80, v81, v82
    v_max3_f32 v20, v83, v84, v85
    v_max3_f32 v19, v19, v86, v87
    v_max3_f32 v19, v19, v20, v16
    s_waitcnt vmcnt(6)
    buffer_load_dwordx4 a[44:47], v2, s[40:43], s67 offen nt
    s_add_u32 s67, s67, s68
    v_mov_b32_dpp v19, v19 quad_perm:[0,0,0,0] row_mask:0xf bank_mask:0xf
    v_mov_b32 v20, v19
    s_nop 1
    v_permlane16_swap_b32 v19, v20
    v_max_f32 v19, v19, v20
    v_mov_b32 v20, v19
    s_nop 1
    v_permlane32_swap_b32 v19, v20
    v_max_f32 v19, v19, v20
    v_mov_b32 v16, v19
    s_waitcnt vmcnt(27)
    v_mfma_f32_16x16x32_bf16 v[32:35], a[96:99], v[4:7], 0
    s_waitcnt vmcnt(26)
    v_mfma_f32_16x16x32_bf16 v[36:39], a[100:103], v[4:7], 0
    s_waitcnt vmcnt(6)
    buffer_load_dwordx4 a[48:51], v2, s[40:43], s67 offen nt
    s_add_u32 s67, s67, s68
    s_waitcnt vmcnt(26)
    v_mfma_f32_16x16x32_bf16 v[40:43], a[104:107], v[4:7], 0
    s_waitcnt vmcnt(25)
    v_mfma_f32_16x16x32_bf16 v[44:47], a[108:111], v[4:7], 0
    s_waitcnt vmcnt(6)
    buffer_load_dwordx4 a[52:55], v2, s[40:43], s67 offen nt
    s_add_u32 s67, s67, s68
    s_waitcnt vmcnt(25)
    v_mfma_f32_16x16x32_bf16 v[48:51], a[112:115], v[4:7], 0
    s_waitcnt vmcnt(24)
    v_mfma_f32_16x16x32_bf16 v[52:55], a[116:119], v[4:7], 0
    s_waitcnt vmcnt(23)
    v_mfma_f32_16x16x32_bf16 v[56:59], a[120:123], v[4:7], 0
    s_waitcnt vmcnt(22)
    s_nop 0
    v_mfma_f32_16x16x32_bf16 v[60:63], a[124:127], v[4:7], 0
    v_add_f32_dpp v32, v33, v32 quad_perm:[1,1,1,1] row_mask:0xf bank_mask:0xf
    v_add_f32_dpp v36, v37, v36 quad_perm:[1,1,1,1] row_mask:0xf bank_mask:0xf
    v_add_f32_dpp v40, v41, v40 quad_perm:[1,1,1,1] row_mask:0xf bank_mask:0xf
    v_add_f32_dpp v44, v45, v44 quad_perm:[1,1,1,1] row_mask:0xf bank_mask:0xf
    v_add_f32_dpp v48, v49, v48 quad_perm:[1,1,1,1] row_mask:0xf bank_mask:0xf
    v_add_f32_dpp v52, v53, v52 quad_perm:[1,1,1,1] row_mask:0xf bank_mask:0xf
    v_add_f32_dpp v56, v57, v56 quad_perm:[1,1,1,1] row_mask:0xf bank_mask:0xf
    s_nop 0
    s_nop 0
    v_add_f32_dpp v60, v61, v60 quad_perm:[1,1,1,1] row_mask:0xf bank_mask:0xf
    v_add_f32_dpp v32, v34, v32 quad_perm:[2,2,2,2] row_mask:0xf bank_mask:0xf
    v_add_f32_dpp v36, v38, v36 quad_perm:[2,2,2,2] row_mask:0xf bank_mask:0xf
    v_add_f32_dpp v40, v42, v40 quad_perm:[2,2,2,2] row_mask:0xf bank_mask:0xf
    v_add_f32_dpp v44, v46, v44 quad_perm:[2,2,2,2] row_mask:0xf bank_mask:0xf
    v_add_f32_dpp v48, v50, v48 quad_perm:[2,2,2,2] row_mask:0xf bank_mask:0xf
    v_add_f32_dpp v52, v54, v52 quad_perm:[2,2,2,2] row_mask:0xf bank_mask:0xf
    v_add_f32_dpp v56, v58, v56 quad_perm:[2,2,2,2] row_mask:0xf bank_mask:0xf
    v_add_f32_dpp v60, v62, v60 quad_perm:[2,2,2,2] row_mask:0xf bank_mask:0xf
    v_add_f32_dpp v88, v35, v32 quad_perm:[3,3,3,3] row_mask:0xf bank_mask:0xf
    v_add_f32_dpp v89, v39, v36 quad_perm:[3,3,3,3] row_mask:0xf bank_mask:0xf
    v_add_f32_dpp v90, v43, v40 quad_perm:[3,3,3,3] row_mask:0xf bank_mask:0xf
    v_add_f32_dpp v91, v47, v44 quad_perm:[3,3,3,3] row_mask:0xf bank_mask:0xf
    v_add_f32_dpp v92, v51, v48 quad_perm:[3,3,3,3] row_mask:0xf bank_mask:0xf
    v_add_f32_dpp v93, v55, v52 quad_perm:[3,3,3,3] row_mask:0xf bank_mask:0xf
    v_add_f32_dpp v94, v59, v56 quad_perm:[3,3,3,3] row_mask:0xf bank_mask:0xf
    v_add_f32_dpp v95, v63, v60 quad_perm:[3,3,3,3] row_mask:0xf bank_mask:0xf
    s_waitcnt vmcnt(6)
    buffer_load_dwordx4 a[56:59], v2, s[40:43], s67 offen nt
    s_add_u32 s67, s67, s68
    v_cvt_pk_bf16_f32 v32, v88, v89
    v_cvt_pk_bf16_f32 v34, v90, v91
    v_cvt_pk_bf16_f32 v36, v92, v93
    v_cvt_pk_bf16_f32 v38, v94, v95
    v_and_b32 v89, 0xffff0000, v32
    v_lshlrev_b32 v88, 16, v32
    v_and_b32 v91, 0xffff0000, v34
    v_lshlrev_b32 v90, 16, v34
    v_and_b32 v93, 0xffff0000, v36
    v_lshlrev_b32 v92, 16, v36
    v_and_b32 v95, 0xffff0000, v38
    v_lshlrev_b32 v94, 16, v38
    v_pk_mul_f32 v[88:89], v[88:89], s[92:93] op_sel_hi:[1,0]
    v_pk_mul_f32 v[90:91], v[90:91], s[92:93] op_sel_hi:[1,0]
    v_pk_mul_f32 v[92:93], v[92:93], s[92:93] op_sel_hi:[1,0]
    v_pk_mul_f32 v[94:95], v[94:95], s[92:93] op_sel_hi:[1,0]
    v_cvt_pk_bf16_f32 v32, v88, v89
    v_cvt_pk_bf16_f32 v34, v90, v91
    v_cvt_pk_bf16_f32 v36, v92, v93
    v_cvt_pk_bf16_f32 v38, v94, v95
    v_and_b32 v89, 0xffff0000, v32
    v_lshlrev_b32 v88, 16, v32
    v_and_b32 v91, 0xffff0000, v34
    v_lshlrev_b32 v90, 16, v34
    v_and_b32 v93, 0xffff0000, v36
    v_lshlrev_b32 v92, 16, v36
    v_and_b32 v95, 0xffff0000, v38
    v_lshlrev_b32 v94, 16, v38
    v_max3_f32 v19, v88, v89, v90
    v_max3_f32 v20, v91, v92, v93
    v_max3_f32 v19, v19, v94, v95
    v_max3_f32 v19, v19, v20, v16
    s_waitcnt vmcnt(6)
    buffer_load_dwordx4 a[60:63], v2, s[40:43], s67 offen nt
    s_add_u32 s67, s67, s68
    v_mov_b32_dpp v19, v19 quad_perm:[0,0,0,0] row_mask:0xf bank_mask:0xf
    v_mov_b32 v20, v19
    s_nop 1
    v_permlane16_swap_b32 v19, v20
    v_max_f32 v19, v19, v20
    v_mov_b32 v20, v19
    s_nop 1
    v_permlane32_swap_b32 v19, v20
    v_max_f32 v19, v19, v20
    v_mov_b32_e64 v16, v19
    v_mul_f32 v19, 0xbfb8aa3b, v19
    v_fmamk_f32 v64, v64, 0x3fb8aa3b, v19
    v_fmamk_f32 v65, v65, 0x3fb8aa3b, v19
    v_fmamk_f32 v66, v66, 0x3fb8aa3b, v19
    v_fmamk_f32 v67, v67, 0x3fb8aa3b, v19
    v_fmamk_f32 v68, v68, 0x3fb8aa3b, v19
    v_fmamk_f32 v69, v69, 0x3fb8aa3b, v19
    v_fmamk_f32 v70, v70, 0x3fb8aa3b, v19
    v_fmamk_f32 v71, v71, 0x3fb8aa3b, v19
    v_exp_f32_dpp v64, v64 quad_perm:[0,0,0,0] row_mask:0xf bank_mask:0xf
    v_exp_f32_dpp v65, v65 quad_perm:[0,0,0,0] row_mask:0xf bank_mask:0xf
    v_exp_f32_dpp v66, v66 quad_perm:[0,0,0,0] row_mask:0xf bank_mask:0xf
    v_exp_f32_dpp v67, v67 quad_perm:[0,0,0,0] row_mask:0xf bank_mask:0xf
    v_exp_f32_dpp v68, v68 quad_perm:[0,0,0,0] row_mask:0xf bank_mask:0xf
    v_exp_f32_dpp v69, v69 quad_perm:[0,0,0,0] row_mask:0xf bank_mask:0xf
    v_exp_f32_dpp v70, v70 quad_perm:[0,0,0,0] row_mask:0xf bank_mask:0xf
    v_exp_f32_dpp v71, v71 quad_perm:[0,0,0,0] row_mask:0xf bank_mask:0xf
    v_add_f32 v20, v64, v65
    v_add_f32 v21, v66, v67
    v_add_f32 v22, v68, v69
    v_add_f32 v23, v70, v71
    v_add_f32 v20, v20, v21
    v_add_f32 v22, v22, v23
    v_add_f32 v17, v17, v20
    v_add_f32 v17, v17, v22
    v_cvt_pk_bf16_f32 v64, v64, v64
    v_cvt_pk_bf16_f32 v65, v65, v65
    v_cvt_pk_bf16_f32 v66, v66, v66
    v_cvt_pk_bf16_f32 v67, v67, v67
    v_cvt_pk_bf16_f32 v68, v68, v68
    v_cvt_pk_bf16_f32 v69, v69, v69
    v_cvt_pk_bf16_f32 v70, v70, v70
    v_cvt_pk_bf16_f32 v71, v71, v71
    v_and_b32 v24, v64, v8
    v_and_b32 v25, v64, v9
    v_and_b32 v26, v64, v10
    v_and_b32 v27, v64, v11
    v_and_b32 v28, v65, v8
    v_and_b32 v29, v65, v9
    v_and_b32 v30, v65, v10
    v_and_b32 v31, v65, v11
    s_waitcnt vmcnt(23)
    v_mfma_f32_16x16x32_bf16 v[12:15], v[96:99], v[24:27], v[12:15]
    v_and_b32 v24, v66, v8
    v_and_b32 v25, v66, v9
    v_and_b32 v26, v66, v10
    v_and_b32 v27, v66, v11
    s_waitcnt vmcnt(22)
    v_mfma_f32_16x16x32_bf16 v[12:15], v[100:103], v[28:31], v[12:15]
    s_waitcnt vmcnt(6)
    buffer_load_dwordx4 a[64:67], v1, s[36:39], s66 offen nt
    s_add_u32 s66, s66, s68
    v_and_b32 v28, v67, v8
    v_and_b32 v29, v67, v9
    v_and_b32 v30, v67, v10
    v_and_b32 v31, v67, v11
    s_waitcnt vmcnt(22)
    v_mfma_f32_16x16x32_bf16 v[12:15], v[104:107], v[24:27], v[12:15]
    v_and_b32 v24, v68, v8
    v_and_b32 v25, v68, v9
    v_and_b32 v26, v68, v10
    v_and_b32 v27, v68, v11
    s_waitcnt vmcnt(21)
    v_mfma_f32_16x16x32_bf16 v[12:15], v[108:111], v[28:31], v[12:15]
    s_waitcnt vmcnt(6)
    buffer_load_dwordx4 a[68:71], v1, s[36:39], s66 offen nt
    s_add_u32 s66, s66, s68
    v_and_b32 v28, v69, v8
    v_and_b32 v29, v69, v9
    v_and_b32 v30, v69, v10
    v_and_b32 v31, v69, v11
    s_waitcnt vmcnt(21)
    v_mfma_f32_16x16x32_bf16 v[12:15], v[112:115], v[24:27], v[12:15]
    v_and_b32 v24, v70, v8
    v_and_b32 v25, v70, v9
    v_and_b32 v26, v70, v10
    v_and_b32 v27, v70, v11
    s_waitcnt vmcnt(20)
    v_mfma_f32_16x16x32_bf16 v[12:15], v[116:119], v[28:31], v[12:15]
    s_waitcnt vmcnt(6)
    buffer_load_dwordx4 a[72:75], v1, s[36:39], s66 offen nt
    s_add_u32 s66, s66, s68
    v_and_b32 v28, v71, v8
    v_and_b32 v29, v71, v9
    v_and_b32 v30, v71, v10
    v_and_b32 v31, v71, v11
    s_waitcnt vmcnt(20)
    v_mfma_f32_16x16x32_bf16 v[12:15], v[120:123], v[24:27], v[12:15]
    s_waitcnt vmcnt(19)
    v_mfma_f32_16x16x32_bf16 v[12:15], v[124:127], v[28:31], v[12:15]
    s_waitcnt vmcnt(6)
    buffer_load_dwordx4 a[76:79], v1, s[36:39], s66 offen nt
    s_add_u32 s66, s66, s68
    s_waitcnt vmcnt(19)
    v_mfma_f32_16x16x32_bf16 v[32:35], a[0:3], v[4:7], 0
    s_waitcnt vmcnt(18)
    v_mfma_f32_16x16x32_bf16 v[36:39], a[4:7], v[4:7], 0
    s_waitcnt vmcnt(6)
    buffer_load_dwordx4 a[80:83], v1, s[36:39], s66 offen nt
    s_add_u32 s66, s66, s68
    s_waitcnt vmcnt(18)
    v_mfma_f32_16x16x32_bf16 v[40:43], a[8:11], v[4:7], 0
    s_waitcnt vmcnt(17)
    v_mfma_f32_16x16x32_bf16 v[44:47], a[12:15], v[4:7], 0
    s_waitcnt vmcnt(6)
    buffer_load_dwordx4 a[84:87], v1, s[36:39], s66 offen nt
    s_add_u32 s66, s66, s68
    s_waitcnt vmcnt(17)
    v_mfma_f32_16x16x32_bf16 v[48:51], a[16:19], v[4:7], 0
    s_waitcnt vmcnt(16)
    v_mfma_f32_16x16x32_bf16 v[52:55], a[20:23], v[4:7], 0
    s_waitcnt vmcnt(15)
    v_mfma_f32_16x16x32_bf16 v[56:59], a[24:27], v[4:7], 0
    s_waitcnt vmcnt(14)
    v_mfma_f32_16x16x32_bf16 v[60:63], a[28:31], v[4:7], 0
    v_add_f32_dpp v32, v33, v32 quad_perm:[1,1,1,1] row_mask:0xf bank_mask:0xf
    v_add_f32_dpp v36, v37, v36 quad_perm:[1,1,1,1] row_mask:0xf bank_mask:0xf
    v_add_f32_dpp v40, v41, v40 quad_perm:[1,1,1,1] row_mask:0xf bank_mask:0xf
    v_add_f32_dpp v44, v45, v44 quad_perm:[1,1,1,1] row_mask:0xf bank_mask:0xf
    v_add_f32_dpp v48, v49, v48 quad_perm:[1,1,1,1] row_mask:0xf bank_mask:0xf
    v_add_f32_dpp v52, v53, v52 quad_perm:[1,1,1,1] row_mask:0xf bank_mask:0xf
    v_add_f32_dpp v56, v57, v56 quad_perm:[1,1,1,1] row_mask:0xf bank_mask:0xf
    s_nop 0
    s_nop 0
    v_add_f32_dpp v60, v61, v60 quad_perm:[1,1,1,1] row_mask:0xf bank_mask:0xf
    v_add_f32_dpp v32, v34, v32 quad_perm:[2,2,2,2] row_mask:0xf bank_mask:0xf
    v_add_f32_dpp v36, v38, v36 quad_perm:[2,2,2,2] row_mask:0xf bank_mask:0xf
    v_add_f32_dpp v40, v42, v40 quad_perm:[2,2,2,2] row_mask:0xf bank_mask:0xf
    v_add_f32_dpp v44, v46, v44 quad_perm:[2,2,2,2] row_mask:0xf bank_mask:0xf
    v_add_f32_dpp v48, v50, v48 quad_perm:[2,2,2,2] row_mask:0xf bank_mask:0xf
    v_add_f32_dpp v52, v54, v52 quad_perm:[2,2,2,2] row_mask:0xf bank_mask:0xf
    v_add_f32_dpp v56, v58, v56 quad_perm:[2,2,2,2] row_mask:0xf bank_mask:0xf
    v_add_f32_dpp v60, v62, v60 quad_perm:[2,2,2,2] row_mask:0xf bank_mask:0xf
    v_add_f32_dpp v64, v35, v32 quad_perm:[3,3,3,3] row_mask:0xf bank_mask:0xf
    v_add_f32_dpp v65, v39, v36 quad_perm:[3,3,3,3] row_mask:0xf bank_mask:0xf
    v_add_f32_dpp v66, v43, v40 quad_perm:[3,3,3,3] row_mask:0xf bank_mask:0xf
    v_add_f32_dpp v67, v47, v44 quad_perm:[3,3,3,3] row_mask:0xf bank_mask:0xf
    v_add_f32_dpp v68, v51, v48 quad_perm:[3,3,3,3] row_mask:0xf bank_mask:0xf
    v_add_f32_dpp v69, v55, v52 quad_perm:[3,3,3,3] row_mask:0xf bank_mask:0xf
    v_add_f32_dpp v70, v59, v56 quad_perm:[3,3,3,3] row_mask:0xf bank_mask:0xf
    v_add_f32_dpp v71, v63, v60 quad_perm:[3,3,3,3] row_mask:0xf bank_mask:0xf
    s_waitcnt vmcnt(6)
    buffer_load_dwordx4 a[88:91], v1, s[36:39], s66 offen nt
    s_add_u32 s66, s66, s68
    v_cvt_pk_bf16_f32 v32, v64, v65
    v_cvt_pk_bf16_f32 v34, v66, v67
    v_cvt_pk_bf16_f32 v36, v68, v69
    v_cvt_pk_bf16_f32 v38, v70, v71
    v_and_b32 v65, 0xffff0000, v32
    v_lshlrev_b32 v64, 16, v32
    v_and_b32 v67, 0xffff0000, v34
    v_lshlrev_b32 v66, 16, v34
    v_and_b32 v69, 0xffff0000, v36
    v_lshlrev_b32 v68, 16, v36
    v_and_b32 v71, 0xffff0000, v38
    v_lshlrev_b32 v70, 16, v38
    v_pk_mul_f32 v[64:65], v[64:65], s[92:93] op_sel_hi:[1,0]
    v_pk_mul_f32 v[66:67], v[66:67], s[92:93] op_sel_hi:[1,0]
    v_pk_mul_f32 v[68:69], v[68:69], s[92:93] op_sel_hi:[1,0]
    v_pk_mul_f32 v[70:71], v[70:71], s[92:93] op_sel_hi:[1,0]
    v_cvt_pk_bf16_f32 v32, v64, v65
    v_cvt_pk_bf16_f32 v34, v66, v67
    v_cvt_pk_bf16_f32 v36, v68, v69
    v_cvt_pk_bf16_f32 v38, v70, v71
    v_and_b32 v65, 0xffff0000, v32
    v_lshlrev_b32 v64, 16, v32
    v_and_b32 v67, 0xffff0000, v34
    v_lshlrev_b32 v66, 16, v34
    v_and_b32 v69, 0xffff0000, v36
    v_lshlrev_b32 v68, 16, v36
    v_and_b32 v71, 0xffff0000, v38
    v_lshlrev_b32 v70, 16, v38
    v_max3_f32 v19, v64, v65, v66
    v_max3_f32 v20, v67, v68, v69
    v_max3_f32 v19, v19, v70, v71
    v_max3_f32 v19, v19, v20, v16
    s_waitcnt vmcnt(6)
    buffer_load_dwordx4 a[92:95], v1, s[36:39], s66 offen nt
    s_add_u32 s66, s66, s68
    v_mov_b32_dpp v19, v19 quad_perm:[0,0,0,0] row_mask:0xf bank_mask:0xf
    v_mov_b32 v20, v19
    s_nop 1
    v_permlane16_swap_b32 v19, v20
    v_max_f32 v19, v19, v20
    v_mov_b32 v20, v19
    s_nop 1
    v_permlane32_swap_b32 v19, v20
    v_max_f32 v19, v19, v20
    v_sub_f32 v18, v16, v19
    v_mul_f32 v18, 0x3fb8aa3b, v18
    v_exp_f32 v18, v18
    v_mov_b32 v16, v19
    v_mul_f32 v19, 0xbfb8aa3b, v19
    v_mul_f32 v17, v17, v18
    v_pk_mul_f32 v[12:13], v[12:13], v[18:19] op_sel_hi:[1,0]
    v_pk_mul_f32 v[14:15], v[14:15], v[18:19] op_sel_hi:[1,0]
    v_fmamk_f32 v72, v72, 0x3fb8aa3b, v19
    v_fmamk_f32 v73, v73, 0x3fb8aa3b, v19
    v_fmamk_f32 v74, v74, 0x3fb8aa3b, v19
    v_fmamk_f32 v75, v75, 0x3fb8aa3b, v19
    v_fmamk_f32 v76, v76, 0x3fb8aa3b, v19
    v_fmamk_f32 v77, v77, 0x3fb8aa3b, v19
    v_fmamk_f32 v78, v78, 0x3fb8aa3b, v19
    v_fmamk_f32 v79, v79, 0x3fb8aa3b, v19
    v_exp_f32_dpp v72, v72 quad_perm:[0,0,0,0] row_mask:0xf bank_mask:0xf
    v_exp_f32_dpp v73, v73 quad_perm:[0,0,0,0] row_mask:0xf bank_mask:0xf
    v_exp_f32_dpp v74, v74 quad_perm:[0,0,0,0] row_mask:0xf bank_mask:0xf
    v_exp_f32_dpp v75, v75 quad_perm:[0,0,0,0] row_mask:0xf bank_mask:0xf
    v_exp_f32_dpp v76, v76 quad_perm:[0,0,0,0] row_mask:0xf bank_mask:0xf
    v_exp_f32_dpp v77, v77 quad_perm:[0,0,0,0] row_mask:0xf bank_mask:0xf
    v_exp_f32_dpp v78, v78 quad_perm:[0,0,0,0] row_mask:0xf bank_mask:0xf
    v_exp_f32_dpp v79, v79 quad_perm:[0,0,0,0] row_mask:0xf bank_mask:0xf
    v_add_f32 v20, v72, v73
    v_add_f32 v21, v74, v75
    v_add_f32 v22, v76, v77
    v_add_f32 v23, v78, v79
    v_add_f32 v20, v20, v21
    v_add_f32 v22, v22, v23
    v_add_f32 v17, v17, v20
    v_add_f32 v17, v17, v22
    v_cvt_pk_bf16_f32 v72, v72, v72
    v_cvt_pk_bf16_f32 v73, v73, v73
    v_cvt_pk_bf16_f32 v74, v74, v74
    v_cvt_pk_bf16_f32 v75, v75, v75
    v_cvt_pk_bf16_f32 v76, v76, v76
    v_cvt_pk_bf16_f32 v77, v77, v77
    v_cvt_pk_bf16_f32 v78, v78, v78
    v_cvt_pk_bf16_f32 v79, v79, v79
    v_and_b32 v24, v72, v8
    v_and_b32 v25, v72, v9
    v_and_b32 v26, v72, v10
    v_and_b32 v27, v72, v11
    v_and_b32 v28, v73, v8
    v_and_b32 v29, v73, v9
    v_and_b32 v30, v73, v10
    v_and_b32 v31, v73, v11
    s_waitcnt vmcnt(15)
    v_mfma_f32_16x16x32_bf16 v[12:15], a[32:35], v[24:27], v[12:15]
    v_and_b32 v24, v74, v8
    v_and_b32 v25, v74, v9
    v_and_b32 v26, v74, v10
    v_and_b32 v27, v74, v11
    s_waitcnt vmcnt(14)
    v_mfma_f32_16x16x32_bf16 v[12:15], a[36:39], v[28:31], v[12:15]
    s_waitcnt vmcnt(6)
    buffer_load_dwordx4 a[96:99], v2, s[40:43], s67 offen nt
    s_add_u32 s67, s67, s68
    v_and_b32 v28, v75, v8
    v_and_b32 v29, v75, v9
    v_and_b32 v30, v75, v10
    v_and_b32 v31, v75, v11
    s_waitcnt vmcnt(14)
    v_mfma_f32_16x16x32_bf16 v[12:15], a[40:43], v[24:27], v[12:15]
    v_and_b32 v24, v76, v8
    v_and_b32 v25, v76, v9
    v_and_b32 v26, v76, v10
    v_and_b32 v27, v76, v11
    s_waitcnt vmcnt(13)
    v_mfma_f32_16x16x32_bf16 v[12:15], a[44:47], v[28:31], v[12:15]
    s_waitcnt vmcnt(6)
    buffer_load_dwordx4 a[100:103], v2, s[40:43], s67 offen nt
    s_add_u32 s67, s67, s68
    v_and_b32 v28, v77, v8
    v_and_b32 v29, v77, v9
    v_and_b32 v30, v77, v10
    v_and_b32 v31, v77, v11
    s_waitcnt vmcnt(13)
    v_mfma_f32_16x16x32_bf16 v[12:15], a[48:51], v[24:27], v[12:15]
    v_and_b32 v24, v78, v8
    v_and_b32 v25, v78, v9
    v_and_b32 v26, v78, v10
    v_and_b32 v27, v78, v11
    s_waitcnt vmcnt(12)
    v_mfma_f32_16x16x32_bf16 v[12:15], a[52:55], v[28:31], v[12:15]
    s_waitcnt vmcnt(6)
    buffer_load_dwordx4 a[104:107], v2, s[40:43], s67 offen nt
    s_add_u32 s67, s67, s68
    v_and_b32 v28, v79, v8
    v_and_b32 v29, v79, v9
    v_and_b32 v30, v79, v10
    v_and_b32 v31, v79, v11
    s_waitcnt vmcnt(12)
    v_mfma_f32_16x16x32_bf16 v[12:15], a[56:59], v[24:27], v[12:15]
    s_waitcnt vmcnt(11)
    v_mfma_f32_16x16x32_bf16 v[12:15], a[60:63], v[28:31], v[12:15]
    s_waitcnt vmcnt(6)
    buffer_load_dwordx4 a[108:111], v2, s[40:43], s67 offen nt
    s_add_u32 s67, s67, s68
    s_waitcnt vmcnt(11)
    v_mfma_f32_16x16x32_bf16 v[32:35], a[64:67], v[4:7], 0
    s_waitcnt vmcnt(6)
    buffer_load_dwordx4 a[112:115], v2, s[40:43], s67 offen nt
    s_add_u32 s67, s67, s68
    s_waitcnt vmcnt(11)
    v_mfma_f32_16x16x32_bf16 v[36:39], a[68:71], v[4:7], 0
    s_waitcnt vmcnt(6)
    buffer_load_dwordx4 a[116:119], v2, s[40:43], s67 offen nt
    s_add_u32 s67, s67, s68
    s_waitcnt vmcnt(11)
    v_mfma_f32_16x16x32_bf16 v[40:43], a[72:75], v[4:7], 0
    s_waitcnt vmcnt(6)
    buffer_load_dwordx4 a[120:123], v2, s[40:43], s67 offen nt
    s_add_u32 s67, s67, s68
    s_waitcnt vmcnt(11)
    v_mfma_f32_16x16x32_bf16 v[44:47], a[76:79], v[4:7], 0
    s_waitcnt vmcnt(6)
    buffer_load_dwordx4 a[124:127], v2, s[40:43], s67 offen nt
    s_add_u32 s67, s67, s68
    s_waitcnt vmcnt(11)
    v_mfma_f32_16x16x32_bf16 v[48:51], a[80:83], v[4:7], 0
    s_waitcnt vmcnt(6)
    buffer_load_dwordx4 v[96:99], v1, s[36:39], s66 offen nt
    s_add_u32 s66, s66, s68
    s_waitcnt vmcnt(11)
    v_mfma_f32_16x16x32_bf16 v[52:55], a[84:87], v[4:7], 0
    s_waitcnt vmcnt(10)
    v_mfma_f32_16x16x32_bf16 v[56:59], a[88:91], v[4:7], 0
    s_waitcnt vmcnt(9)
    v_mfma_f32_16x16x32_bf16 v[60:63], a[92:95], v[4:7], 0
    v_add_f32_dpp v32, v33, v32 quad_perm:[1,1,1,1] row_mask:0xf bank_mask:0xf
    v_add_f32_dpp v36, v37, v36 quad_perm:[1,1,1,1] row_mask:0xf bank_mask:0xf
    v_add_f32_dpp v40, v41, v40 quad_perm:[1,1,1,1] row_mask:0xf bank_mask:0xf
    v_add_f32_dpp v44, v45, v44 quad_perm:[1,1,1,1] row_mask:0xf bank_mask:0xf
    v_add_f32_dpp v48, v49, v48 quad_perm:[1,1,1,1] row_mask:0xf bank_mask:0xf
    v_add_f32_dpp v52, v53, v52 quad_perm:[1,1,1,1] row_mask:0xf bank_mask:0xf
    v_add_f32_dpp v56, v57, v56 quad_perm:[1,1,1,1] row_mask:0xf bank_mask:0xf
    s_nop 0
    s_nop 0
    v_add_f32_dpp v60, v61, v60 quad_perm:[1,1,1,1] row_mask:0xf bank_mask:0xf
    v_add_f32_dpp v32, v34, v32 quad_perm:[2,2,2,2] row_mask:0xf bank_mask:0xf
    v_add_f32_dpp v36, v38, v36 quad_perm:[2,2,2,2] row_mask:0xf bank_mask:0xf
    v_add_f32_dpp v40, v42, v40 quad_perm:[2,2,2,2] row_mask:0xf bank_mask:0xf
    v_add_f32_dpp v44, v46, v44 quad_perm:[2,2,2,2] row_mask:0xf bank_mask:0xf
    v_add_f32_dpp v48, v50, v48 quad_perm:[2,2,2,2] row_mask:0xf bank_mask:0xf
    v_add_f32_dpp v52, v54, v52 quad_perm:[2,2,2,2] row_mask:0xf bank_mask:0xf
    v_add_f32_dpp v56, v58, v56 quad_perm:[2,2,2,2] row_mask:0xf bank_mask:0xf
    v_add_f32_dpp v60, v62, v60 quad_perm:[2,2,2,2] row_mask:0xf bank_mask:0xf
    v_add_f32_dpp v72, v35, v32 quad_perm:[3,3,3,3] row_mask:0xf bank_mask:0xf
    v_add_f32_dpp v73, v39, v36 quad_perm:[3,3,3,3] row_mask:0xf bank_mask:0xf
    v_add_f32_dpp v74, v43, v40 quad_perm:[3,3,3,3] row_mask:0xf bank_mask:0xf
    v_add_f32_dpp v75, v47, v44 quad_perm:[3,3,3,3] row_mask:0xf bank_mask:0xf
    v_add_f32_dpp v76, v51, v48 quad_perm:[3,3,3,3] row_mask:0xf bank_mask:0xf
    v_add_f32_dpp v77, v55, v52 quad_perm:[3,3,3,3] row_mask:0xf bank_mask:0xf
    v_add_f32_dpp v78, v59, v56 quad_perm:[3,3,3,3] row_mask:0xf bank_mask:0xf
    v_add_f32_dpp v79, v63, v60 quad_perm:[3,3,3,3] row_mask:0xf bank_mask:0xf
    s_waitcnt vmcnt(6)
    buffer_load_dwordx4 v[100:103], v1, s[36:39], s66 offen nt
    s_add_u32 s66, s66, s68
    v_cvt_pk_bf16_f32 v32, v72, v73
    v_cvt_pk_bf16_f32 v34, v74, v75
    v_cvt_pk_bf16_f32 v36, v76, v77
    v_cvt_pk_bf16_f32 v38, v78, v79
    v_and_b32 v73, 0xffff0000, v32
    v_lshlrev_b32 v72, 16, v32
    v_and_b32 v75, 0xffff0000, v34
    v_lshlrev_b32 v74, 16, v34
    v_and_b32 v77, 0xffff0000, v36
    v_lshlrev_b32 v76, 16, v36
    v_and_b32 v79, 0xffff0000, v38
    v_lshlrev_b32 v78, 16, v38
    v_pk_mul_f32 v[72:73], v[72:73], s[92:93] op_sel_hi:[1,0]
    v_pk_mul_f32 v[74:75], v[74:75], s[92:93] op_sel_hi:[1,0]
    v_pk_mul_f32 v[76:77], v[76:77], s[92:93] op_sel_hi:[1,0]
    v_pk_mul_f32 v[78:79], v[78:79], s[92:93] op_sel_hi:[1,0]
    v_cvt_pk_bf16_f32 v32, v72, v73
    v_cvt_pk_bf16_f32 v34, v74, v75
    v_cvt_pk_bf16_f32 v36, v76, v77
    v_cvt_pk_bf16_f32 v38, v78, v79
    v_and_b32 v73, 0xffff0000, v32
    v_lshlrev_b32 v72, 16, v32
    v_and_b32 v75, 0xffff0000, v34
    v_lshlrev_b32 v74, 16, v34
    v_and_b32 v77, 0xffff0000, v36
    v_lshlrev_b32 v76, 16, v36
    v_and_b32 v79, 0xffff0000, v38
    v_lshlrev_b32 v78, 16, v38
    v_max3_f32 v19, v72, v73, v74
    v_max3_f32 v20, v75, v76, v77
    v_max3_f32 v19, v19, v78, v79
    v_max3_f32 v19, v19, v20, v16
    s_waitcnt vmcnt(6)
    buffer_load_dwordx4 v[104:107], v1, s[36:39], s66 offen nt
    s_add_u32 s66, s66, s68
    v_mov_b32_dpp v19, v19 quad_perm:[0,0,0,0] row_mask:0xf bank_mask:0xf
    v_mov_b32 v20, v19
    s_nop 1
    v_permlane16_swap_b32 v19, v20
    v_max_f32 v19, v19, v20
    v_mov_b32 v20, v19
    s_nop 1
    v_permlane32_swap_b32 v19, v20
    v_max_f32 v19, v19, v20
    v_sub_f32 v18, v16, v19
    v_mul_f32 v18, 0x3fb8aa3b, v18
    v_exp_f32 v18, v18
    v_mov_b32 v16, v19
    v_mul_f32 v19, 0xbfb8aa3b, v19
    v_mul_f32 v17, v17, v18
    v_pk_mul_f32 v[12:13], v[12:13], v[18:19] op_sel_hi:[1,0]
    v_pk_mul_f32 v[14:15], v[14:15], v[18:19] op_sel_hi:[1,0]
    s_waitcnt vmcnt(6)
    buffer_load_dwordx4 v[108:111], v1, s[36:39], s66 offen nt
    s_add_u32 s66, s66, s68
    v_fmamk_f32 v80, v80, 0x3fb8aa3b, v19
    v_fmamk_f32 v81, v81, 0x3fb8aa3b, v19
    v_fmamk_f32 v82, v82, 0x3fb8aa3b, v19
    v_fmamk_f32 v83, v83, 0x3fb8aa3b, v19
    v_fmamk_f32 v84, v84, 0x3fb8aa3b, v19
    v_fmamk_f32 v85, v85, 0x3fb8aa3b, v19
    v_fmamk_f32 v86, v86, 0x3fb8aa3b, v19
    v_fmamk_f32 v87, v87, 0x3fb8aa3b, v19
    v_exp_f32_dpp v80, v80 quad_perm:[0,0,0,0] row_mask:0xf bank_mask:0xf
    v_exp_f32_dpp v81, v81 quad_perm:[0,0,0,0] row_mask:0xf bank_mask:0xf
    v_exp_f32_dpp v82, v82 quad_perm:[0,0,0,0] row_mask:0xf bank_mask:0xf
    v_exp_f32_dpp v83, v83 quad_perm:[0,0,0,0] row_mask:0xf bank_mask:0xf
    v_exp_f32_dpp v84, v84 quad_perm:[0,0,0,0] row_mask:0xf bank_mask:0xf
    v_exp_f32_dpp v85, v85 quad_perm:[0,0,0,0] row_mask:0xf bank_mask:0xf
    v_exp_f32_dpp v86, v86 quad_perm:[0,0,0,0] row_mask:0xf bank_mask:0xf
    v_exp_f32_dpp v87, v87 quad_perm:[0,0,0,0] row_mask:0xf bank_mask:0xf
    v_add_f32 v20, v80, v81
    v_add_f32 v21, v82, v83
    v_add_f32 v22, v84, v85
    v_add_f32 v23, v86, v87
    v_add_f32 v20, v20, v21
    v_add_f32 v22, v22, v23
    v_add_f32 v17, v17, v20
    v_add_f32 v17, v17, v22
    v_cvt_pk_bf16_f32 v80, v80, v80
    v_cvt_pk_bf16_f32 v81, v81, v81
    v_cvt_pk_bf16_f32 v82, v82, v82
    v_cvt_pk_bf16_f32 v83, v83, v83
    v_cvt_pk_bf16_f32 v84, v84, v84
    v_cvt_pk_bf16_f32 v85, v85, v85
    v_cvt_pk_bf16_f32 v86, v86, v86
    v_cvt_pk_bf16_f32 v87, v87, v87
    v_and_b32 v24, v80, v8
    v_and_b32 v25, v80, v9
    v_and_b32 v26, v80, v10
    v_and_b32 v27, v80, v11
    v_and_b32 v28, v81, v8
    v_and_b32 v29, v81, v9
    v_and_b32 v30, v81, v10
    v_and_b32 v31, v81, v11
    s_waitcnt vmcnt(11)
    v_mfma_f32_16x16x32_bf16 v[12:15], a[96:99], v[24:27], v[12:15]
    s_waitcnt vmcnt(6)
    buffer_load_dwordx4 v[112:115], v1, s[36:39], s66 offen nt
    s_add_u32 s66, s66, s68
    v_and_b32 v24, v82, v8
    v_and_b32 v25, v82, v9
    v_and_b32 v26, v82, v10
    v_and_b32 v27, v82, v11
    s_waitcnt vmcnt(11)
    v_mfma_f32_16x16x32_bf16 v[12:15], a[100:103], v[28:31], v[12:15]
    s_waitcnt vmcnt(6)
    buffer_load_dwordx4 v[116:119], v1, s[36:39], s66 offen nt
    s_add_u32 s66, s66, s68
    v_and_b32 v28, v83, v8
    v_and_b32 v29, v83, v9
    v_and_b32 v30, v83, v10
    v_and_b32 v31, v83, v11
    s_waitcnt vmcnt(11)
    v_mfma_f32_16x16x32_bf16 v[12:15], a[104:107], v[24:27], v[12:15]
    s_waitcnt vmcnt(6)
    buffer_load_dwordx4 v[120:123], v1, s[36:39], s66 offen nt
    s_add_u32 s66, s66, s68
    v_and_b32 v24, v84, v8
    v_and_b32 v25, v84, v9
    v_and_b32 v26, v84, v10
    v_and_b32 v27, v84, v11
    s_waitcnt vmcnt(11)
    v_mfma_f32_16x16x32_bf16 v[12:15], a[108:111], v[28:31], v[12:15]
    s_waitcnt vmcnt(6)
    buffer_load_dwordx4 v[124:127], v1, s[36:39], s66 offen nt
    s_add_u32 s66, s66, s68
    v_and_b32 v28, v85, v8
    v_and_b32 v29, v85, v9
    v_and_b32 v30, v85, v10
    v_and_b32 v31, v85, v11
    s_waitcnt vmcnt(11)
    v_mfma_f32_16x16x32_bf16 v[12:15], a[112:115], v[24:27], v[12:15]
    s_waitcnt vmcnt(6)
    buffer_load_dwordx4 a[0:3], v2, s[40:43], s67 offen nt
    s_add_u32 s67, s67, s68
    v_and_b32 v24, v86, v8
    v_and_b32 v25, v86, v9
    v_and_b32 v26, v86, v10
    v_and_b32 v27, v86, v11
    s_waitcnt vmcnt(11)
    v_mfma_f32_16x16x32_bf16 v[12:15], a[116:119], v[28:31], v[12:15]
    s_waitcnt vmcnt(6)
    buffer_load_dwordx4 a[4:7], v2, s[40:43], s67 offen nt
    s_add_u32 s67, s67, s68
    v_and_b32 v28, v87, v8
    v_and_b32 v29, v87, v9
    v_and_b32 v30, v87, v10
    v_and_b32 v31, v87, v11
    s_waitcnt vmcnt(11)
    v_mfma_f32_16x16x32_bf16 v[12:15], a[120:123], v[24:27], v[12:15]
    s_waitcnt vmcnt(6)
    buffer_load_dwordx4 a[8:11], v2, s[40:43], s67 offen nt
    s_add_u32 s67, s67, s68
    s_waitcnt vmcnt(11)
    v_mfma_f32_16x16x32_bf16 v[12:15], a[124:127], v[28:31], v[12:15]
    s_waitcnt vmcnt(6)
    buffer_load_dwordx4 a[12:15], v2, s[40:43], s67 offen nt
    s_add_u32 s67, s67, s68
    s_waitcnt vmcnt(11)
    v_mfma_f32_16x16x32_bf16 v[32:35], v[96:99], v[4:7], 0
    s_waitcnt vmcnt(6)
    buffer_load_dwordx4 a[16:19], v2, s[40:43], s67 offen nt
    s_add_u32 s67, s67, s68
    s_waitcnt vmcnt(11)
    v_mfma_f32_16x16x32_bf16 v[36:39], v[100:103], v[4:7], 0
    s_waitcnt vmcnt(6)
    buffer_load_dwordx4 a[20:23], v2, s[40:43], s67 offen nt
    s_add_u32 s67, s67, s68
    s_waitcnt vmcnt(11)
    v_mfma_f32_16x16x32_bf16 v[40:43], v[104:107], v[4:7], 0
    s_waitcnt vmcnt(6)
    buffer_load_dwordx4 a[24:27], v2, s[40:43], s67 offen nt
    s_add_u32 s67, s67, s68
    s_waitcnt vmcnt(11)
    v_mfma_f32_16x16x32_bf16 v[44:47], v[108:111], v[4:7], 0
    s_waitcnt vmcnt(6)
    buffer_load_dwordx4 a[28:31], v2, s[40:43], s67 offen nt
    s_add_u32 s67, s67, s68
    s_waitcnt vmcnt(11)
    v_mfma_f32_16x16x32_bf16 v[48:51], v[112:115], v[4:7], 0
    s_waitcnt vmcnt(6)
    buffer_load_dwordx4 a[32:35], v1, s[36:39], s66 offen nt
    s_add_u32 s66, s66, s68
    s_waitcnt vmcnt(11)
    v_mfma_f32_16x16x32_bf16 v[52:55], v[116:119], v[4:7], 0
    s_waitcnt vmcnt(10)
    v_mfma_f32_16x16x32_bf16 v[56:59], v[120:123], v[4:7], 0
    s_waitcnt vmcnt(9)
    v_mfma_f32_16x16x32_bf16 v[60:63], v[124:127], v[4:7], 0
    v_add_f32_dpp v32, v33, v32 quad_perm:[1,1,1,1] row_mask:0xf bank_mask:0xf
    v_add_f32_dpp v36, v37, v36 quad_perm:[1,1,1,1] row_mask:0xf bank_mask:0xf
    v_add_f32_dpp v40, v41, v40 quad_perm:[1,1,1,1] row_mask:0xf bank_mask:0xf
    v_add_f32_dpp v44, v45, v44 quad_perm:[1,1,1,1] row_mask:0xf bank_mask:0xf
    v_add_f32_dpp v48, v49, v48 quad_perm:[1,1,1,1] row_mask:0xf bank_mask:0xf
    v_add_f32_dpp v52, v53, v52 quad_perm:[1,1,1,1] row_mask:0xf bank_mask:0xf
    v_add_f32_dpp v56, v57, v56 quad_perm:[1,1,1,1] row_mask:0xf bank_mask:0xf
    s_nop 0
    s_nop 0
    v_add_f32_dpp v60, v61, v60 quad_perm:[1,1,1,1] row_mask:0xf bank_mask:0xf
    v_add_f32_dpp v32, v34, v32 quad_perm:[2,2,2,2] row_mask:0xf bank_mask:0xf
    v_add_f32_dpp v36, v38, v36 quad_perm:[2,2,2,2] row_mask:0xf bank_mask:0xf
    v_add_f32_dpp v40, v42, v40 quad_perm:[2,2,2,2] row_mask:0xf bank_mask:0xf
    v_add_f32_dpp v44, v46, v44 quad_perm:[2,2,2,2] row_mask:0xf bank_mask:0xf
    v_add_f32_dpp v48, v50, v48 quad_perm:[2,2,2,2] row_mask:0xf bank_mask:0xf
    v_add_f32_dpp v52, v54, v52 quad_perm:[2,2,2,2] row_mask:0xf bank_mask:0xf
    v_add_f32_dpp v56, v58, v56 quad_perm:[2,2,2,2] row_mask:0xf bank_mask:0xf
    v_add_f32_dpp v60, v62, v60 quad_perm:[2,2,2,2] row_mask:0xf bank_mask:0xf
    v_add_f32_dpp v80, v35, v32 quad_perm:[3,3,3,3] row_mask:0xf bank_mask:0xf
    v_add_f32_dpp v81, v39, v36 quad_perm:[3,3,3,3] row_mask:0xf bank_mask:0xf
    v_add_f32_dpp v82, v43, v40 quad_perm:[3,3,3,3] row_mask:0xf bank_mask:0xf
    v_add_f32_dpp v83, v47, v44 quad_perm:[3,3,3,3] row_mask:0xf bank_mask:0xf
    v_add_f32_dpp v84, v51, v48 quad_perm:[3,3,3,3] row_mask:0xf bank_mask:0xf
    v_add_f32_dpp v85, v55, v52 quad_perm:[3,3,3,3] row_mask:0xf bank_mask:0xf
    v_add_f32_dpp v86, v59, v56 quad_perm:[3,3,3,3] row_mask:0xf bank_mask:0xf
    v_add_f32_dpp v87, v63, v60 quad_perm:[3,3,3,3] row_mask:0xf bank_mask:0xf
    s_waitcnt vmcnt(6)
    buffer_load_dwordx4 a[36:39], v1, s[36:39], s66 offen nt
    s_add_u32 s66, s66, s68
    v_cvt_pk_bf16_f32 v32, v80, v81
    v_cvt_pk_bf16_f32 v34, v82, v83
    v_cvt_pk_bf16_f32 v36, v84, v85
    v_cvt_pk_bf16_f32 v38, v86, v87
    v_and_b32 v81, 0xffff0000, v32
    v_lshlrev_b32 v80, 16, v32
    v_and_b32 v83, 0xffff0000, v34
    v_lshlrev_b32 v82, 16, v34
    v_and_b32 v85, 0xffff0000, v36
    v_lshlrev_b32 v84, 16, v36
    v_and_b32 v87, 0xffff0000, v38
    v_lshlrev_b32 v86, 16, v38
    v_pk_mul_f32 v[80:81], v[80:81], s[92:93] op_sel_hi:[1,0]
    v_pk_mul_f32 v[82:83], v[82:83], s[92:93] op_sel_hi:[1,0]
    v_pk_mul_f32 v[84:85], v[84:85], s[92:93] op_sel_hi:[1,0]
    v_pk_mul_f32 v[86:87], v[86:87], s[92:93] op_sel_hi:[1,0]
    v_cvt_pk_bf16_f32 v32, v80, v81
    v_cvt_pk_bf16_f32 v34, v82, v83
    v_cvt_pk_bf16_f32 v36, v84, v85
    v_cvt_pk_bf16_f32 v38, v86, v87
    v_and_b32 v81, 0xffff0000, v32
    v_lshlrev_b32 v80, 16, v32
    v_and_b32 v83, 0xffff0000, v34
    v_lshlrev_b32 v82, 16, v34
    v_and_b32 v85, 0xffff0000, v36
    v_lshlrev_b32 v84, 16, v36
    v_and_b32 v87, 0xffff0000, v38
    v_lshlrev_b32 v86, 16, v38
    v_max3_f32 v19, v80, v81, v82
    v_max3_f32 v20, v83, v84, v85
    v_max3_f32 v19, v19, v86, v87
    v_max3_f32 v19, v19, v20, v16
    s_waitcnt vmcnt(6)
    buffer_load_dwordx4 a[40:43], v1, s[36:39], s66 offen nt
    s_add_u32 s66, s66, s68
    v_mov_b32_dpp v19, v19 quad_perm:[0,0,0,0] row_mask:0xf bank_mask:0xf
    v_mov_b32 v20, v19
    s_nop 1
    v_permlane16_swap_b32 v19, v20
    v_max_f32 v19, v19, v20
    v_mov_b32 v20, v19
    s_nop 1
    v_permlane32_swap_b32 v19, v20
    v_max_f32 v19, v19, v20
    v_sub_f32 v18, v16, v19
    v_mul_f32 v18, 0x3fb8aa3b, v18
    v_exp_f32 v18, v18
    v_mov_b32 v16, v19
    v_mul_f32 v19, 0xbfb8aa3b, v19
    v_mul_f32 v17, v17, v18
    v_pk_mul_f32 v[12:13], v[12:13], v[18:19] op_sel_hi:[1,0]
    v_pk_mul_f32 v[14:15], v[14:15], v[18:19] op_sel_hi:[1,0]
    s_waitcnt vmcnt(6)
    buffer_load_dwordx4 a[44:47], v1, s[36:39], s66 offen nt
    s_add_u32 s66, s66, s68
    v_fmamk_f32 v88, v88, 0x3fb8aa3b, v19
    v_fmamk_f32 v89, v89, 0x3fb8aa3b, v19
    v_fmamk_f32 v90, v90, 0x3fb8aa3b, v19
    v_fmamk_f32 v91, v91, 0x3fb8aa3b, v19
    v_fmamk_f32 v92, v92, 0x3fb8aa3b, v19
    v_fmamk_f32 v93, v93, 0x3fb8aa3b, v19
    v_fmamk_f32 v94, v94, 0x3fb8aa3b, v19
    v_fmamk_f32 v95, v95, 0x3fb8aa3b, v19
    v_exp_f32_dpp v88, v88 quad_perm:[0,0,0,0] row_mask:0xf bank_mask:0xf
    v_exp_f32_dpp v89, v89 quad_perm:[0,0,0,0] row_mask:0xf bank_mask:0xf
    v_exp_f32_dpp v90, v90 quad_perm:[0,0,0,0] row_mask:0xf bank_mask:0xf
    v_exp_f32_dpp v91, v91 quad_perm:[0,0,0,0] row_mask:0xf bank_mask:0xf
    v_exp_f32_dpp v92, v92 quad_perm:[0,0,0,0] row_mask:0xf bank_mask:0xf
    v_exp_f32_dpp v93, v93 quad_perm:[0,0,0,0] row_mask:0xf bank_mask:0xf
    v_exp_f32_dpp v94, v94 quad_perm:[0,0,0,0] row_mask:0xf bank_mask:0xf
    v_exp_f32_dpp v95, v95 quad_perm:[0,0,0,0] row_mask:0xf bank_mask:0xf
    v_add_f32 v20, v88, v89
    v_add_f32 v21, v90, v91
    v_add_f32 v22, v92, v93
    v_add_f32 v23, v94, v95
    v_add_f32 v20, v20, v21
    v_add_f32 v22, v22, v23
    v_add_f32 v17, v17, v20
    v_add_f32 v17, v17, v22
    v_cvt_pk_bf16_f32 v88, v88, v88
    v_cvt_pk_bf16_f32 v89, v89, v89
    v_cvt_pk_bf16_f32 v90, v90, v90
    v_cvt_pk_bf16_f32 v91, v91, v91
    v_cvt_pk_bf16_f32 v92, v92, v92
    v_cvt_pk_bf16_f32 v93, v93, v93
    v_cvt_pk_bf16_f32 v94, v94, v94
    v_cvt_pk_bf16_f32 v95, v95, v95
    v_and_b32 v24, v88, v8
    v_and_b32 v25, v88, v9
    v_and_b32 v26, v88, v10
    v_and_b32 v27, v88, v11
    v_and_b32 v28, v89, v8
    v_and_b32 v29, v89, v9
    v_and_b32 v30, v89, v10
    v_and_b32 v31, v89, v11
    s_waitcnt vmcnt(11)
    v_mfma_f32_16x16x32_bf16 v[12:15], a[0:3], v[24:27], v[12:15]
    s_waitcnt vmcnt(6)
    buffer_load_dwordx4 a[48:51], v1, s[36:39], s66 offen nt
    s_add_u32 s66, s66, s68
    v_and_b32 v24, v90, v8
    v_and_b32 v25, v90, v9
    v_and_b32 v26, v90, v10
    v_and_b32 v27, v90, v11
    s_waitcnt vmcnt(11)
    v_mfma_f32_16x16x32_bf16 v[12:15], a[4:7], v[28:31], v[12:15]
    s_waitcnt vmcnt(6)
    buffer_load_dwordx4 a[52:55], v1, s[36:39], s66 offen nt
    s_add_u32 s66, s66, s68
    v_and_b32 v28, v91, v8
    v_and_b32 v29, v91, v9
    v_and_b32 v30, v91, v10
    v_and_b32 v31, v91, v11
    s_waitcnt vmcnt(11)
    v_mfma_f32_16x16x32_bf16 v[12:15], a[8:11], v[24:27], v[12:15]
    s_waitcnt vmcnt(6)
    buffer_load_dwordx4 a[56:59], v1, s[36:39], s66 offen nt
    s_add_u32 s66, s66, s68
    v_and_b32 v24, v92, v8
    v_and_b32 v25, v92, v9
    v_and_b32 v26, v92, v10
    v_and_b32 v27, v92, v11
    s_waitcnt vmcnt(11)
    v_mfma_f32_16x16x32_bf16 v[12:15], a[12:15], v[28:31], v[12:15]
    s_waitcnt vmcnt(6)
    buffer_load_dwordx4 a[60:63], v1, s[36:39], s66 offen nt
    s_add_u32 s66, s66, s68
    v_and_b32 v28, v93, v8
    v_and_b32 v29, v93, v9
    v_and_b32 v30, v93, v10
    v_and_b32 v31, v93, v11
    s_waitcnt vmcnt(11)
    v_mfma_f32_16x16x32_bf16 v[12:15], a[16:19], v[24:27], v[12:15]
    s_waitcnt vmcnt(6)
    buffer_load_dwordx4 a[64:67], v2, s[40:43], s67 offen nt
    s_add_u32 s67, s67, s68
    v_and_b32 v24, v94, v8
    v_and_b32 v25, v94, v9
    v_and_b32 v26, v94, v10
    v_and_b32 v27, v94, v11
    s_waitcnt vmcnt(11)
    v_mfma_f32_16x16x32_bf16 v[12:15], a[20:23], v[28:31], v[12:15]
    s_waitcnt vmcnt(6)
    buffer_load_dwordx4 a[68:71], v2, s[40:43], s67 offen nt
    s_add_u32 s67, s67, s68
    v_and_b32 v28, v95, v8
    v_and_b32 v29, v95, v9
    v_and_b32 v30, v95, v10
    v_and_b32 v31, v95, v11
    s_waitcnt vmcnt(11)
    v_mfma_f32_16x16x32_bf16 v[12:15], a[24:27], v[24:27], v[12:15]
    s_waitcnt vmcnt(6)
    buffer_load_dwordx4 a[72:75], v2, s[40:43], s67 offen nt
    s_add_u32 s67, s67, s68
    s_waitcnt vmcnt(11)
    v_mfma_f32_16x16x32_bf16 v[12:15], a[28:31], v[28:31], v[12:15]
    s_waitcnt vmcnt(6)
    buffer_load_dwordx4 a[76:79], v2, s[40:43], s67 offen nt
    s_add_u32 s67, s67, s68
    s_waitcnt vmcnt(11)
    v_mfma_f32_16x16x32_bf16 v[32:35], a[32:35], v[4:7], 0
    s_waitcnt vmcnt(6)
    buffer_load_dwordx4 a[80:83], v2, s[40:43], s67 offen nt
    s_add_u32 s67, s67, s68
    s_waitcnt vmcnt(11)
    v_mfma_f32_16x16x32_bf16 v[36:39], a[36:39], v[4:7], 0
    s_waitcnt vmcnt(6)
    buffer_load_dwordx4 a[84:87], v2, s[40:43], s67 offen nt
    s_add_u32 s67, s67, s68
    s_waitcnt vmcnt(11)
    v_mfma_f32_16x16x32_bf16 v[40:43], a[40:43], v[4:7], 0
    s_waitcnt vmcnt(6)
    buffer_load_dwordx4 a[88:91], v2, s[40:43], s67 offen nt
    s_add_u32 s67, s67, s68
    s_waitcnt vmcnt(11)
    v_mfma_f32_16x16x32_bf16 v[44:47], a[44:47], v[4:7], 0
    s_waitcnt vmcnt(6)
    buffer_load_dwordx4 a[92:95], v2, s[40:43], s67 offen nt
    s_add_u32 s67, s67, s68
    s_waitcnt vmcnt(11)
    v_mfma_f32_16x16x32_bf16 v[48:51], a[48:51], v[4:7], 0
    s_waitcnt vmcnt(6)
    buffer_load_dwordx4 a[96:99], v2, s[40:43], s67 offen nt
    s_add_u32 s67, s67, s68
    s_waitcnt vmcnt(11)
    v_mfma_f32_16x16x32_bf16 v[52:55], a[52:55], v[4:7], 0
    s_waitcnt vmcnt(10)
    v_mfma_f32_16x16x32_bf16 v[56:59], a[56:59], v[4:7], 0
    s_waitcnt vmcnt(9)
    v_mfma_f32_16x16x32_bf16 v[60:63], a[60:63], v[4:7], 0
    v_add_f32_dpp v32, v33, v32 quad_perm:[1,1,1,1] row_mask:0xf bank_mask:0xf
    v_add_f32_dpp v36, v37, v36 quad_perm:[1,1,1,1] row_mask:0xf bank_mask:0xf
    v_add_f32_dpp v40, v41, v40 quad_perm:[1,1,1,1] row_mask:0xf bank_mask:0xf
    v_add_f32_dpp v44, v45, v44 quad_perm:[1,1,1,1] row_mask:0xf bank_mask:0xf
    v_add_f32_dpp v48, v49, v48 quad_perm:[1,1,1,1] row_mask:0xf bank_mask:0xf
    v_add_f32_dpp v52, v53, v52 quad_perm:[1,1,1,1] row_mask:0xf bank_mask:0xf
    v_add_f32_dpp v56, v57, v56 quad_perm:[1,1,1,1] row_mask:0xf bank_mask:0xf
    s_nop 0
    s_nop 0
    v_add_f32_dpp v60, v61, v60 quad_perm:[1,1,1,1] row_mask:0xf bank_mask:0xf
    v_add_f32_dpp v32, v34, v32 quad_perm:[2,2,2,2] row_mask:0xf bank_mask:0xf
    v_add_f32_dpp v36, v38, v36 quad_perm:[2,2,2,2] row_mask:0xf bank_mask:0xf
    v_add_f32_dpp v40, v42, v40 quad_perm:[2,2,2,2] row_mask:0xf bank_mask:0xf
    v_add_f32_dpp v44, v46, v44 quad_perm:[2,2,2,2] row_mask:0xf bank_mask:0xf
    v_add_f32_dpp v48, v50, v48 quad_perm:[2,2,2,2] row_mask:0xf bank_mask:0xf
    v_add_f32_dpp v52, v54, v52 quad_perm:[2,2,2,2] row_mask:0xf bank_mask:0xf
    v_add_f32_dpp v56, v58, v56 quad_perm:[2,2,2,2] row_mask:0xf bank_mask:0xf
    v_add_f32_dpp v60, v62, v60 quad_perm:[2,2,2,2] row_mask:0xf bank_mask:0xf
    v_add_f32_dpp v88, v35, v32 quad_perm:[3,3,3,3] row_mask:0xf bank_mask:0xf
    v_add_f32_dpp v89, v39, v36 quad_perm:[3,3,3,3] row_mask:0xf bank_mask:0xf
    v_add_f32_dpp v90, v43, v40 quad_perm:[3,3,3,3] row_mask:0xf bank_mask:0xf
    v_add_f32_dpp v91, v47, v44 quad_perm:[3,3,3,3] row_mask:0xf bank_mask:0xf
    v_add_f32_dpp v92, v51, v48 quad_perm:[3,3,3,3] row_mask:0xf bank_mask:0xf
    v_add_f32_dpp v93, v55, v52 quad_perm:[3,3,3,3] row_mask:0xf bank_mask:0xf
    v_add_f32_dpp v94, v59, v56 quad_perm:[3,3,3,3] row_mask:0xf bank_mask:0xf
    v_add_f32_dpp v95, v63, v60 quad_perm:[3,3,3,3] row_mask:0xf bank_mask:0xf
    s_waitcnt vmcnt(6)
    buffer_load_dwordx4 a[100:103], v2, s[40:43], s67 offen nt
    s_add_u32 s67, s67, s68
    v_cvt_pk_bf16_f32 v32, v88, v89
    v_cvt_pk_bf16_f32 v34, v90, v91
    v_cvt_pk_bf16_f32 v36, v92, v93
    v_cvt_pk_bf16_f32 v38, v94, v95
    v_and_b32 v89, 0xffff0000, v32
    v_lshlrev_b32 v88, 16, v32
    v_and_b32 v91, 0xffff0000, v34
    v_lshlrev_b32 v90, 16, v34
    v_and_b32 v93, 0xffff0000, v36
    v_lshlrev_b32 v92, 16, v36
    v_and_b32 v95, 0xffff0000, v38
    v_lshlrev_b32 v94, 16, v38
    v_pk_mul_f32 v[88:89], v[88:89], s[92:93] op_sel_hi:[1,0]
    v_pk_mul_f32 v[90:91], v[90:91], s[92:93] op_sel_hi:[1,0]
    v_pk_mul_f32 v[92:93], v[92:93], s[92:93] op_sel_hi:[1,0]
    v_pk_mul_f32 v[94:95], v[94:95], s[92:93] op_sel_hi:[1,0]
    v_cvt_pk_bf16_f32 v32, v88, v89
    v_cvt_pk_bf16_f32 v34, v90, v91
    v_cvt_pk_bf16_f32 v36, v92, v93
    v_cvt_pk_bf16_f32 v38, v94, v95
    v_and_b32 v89, 0xffff0000, v32
    v_lshlrev_b32 v88, 16, v32
    v_and_b32 v91, 0xffff0000, v34
    v_lshlrev_b32 v90, 16, v34
    v_and_b32 v93, 0xffff0000, v36
    v_lshlrev_b32 v92, 16, v36
    v_and_b32 v95, 0xffff0000, v38
    v_lshlrev_b32 v94, 16, v38
    v_max3_f32 v19, v88, v89, v90
    v_max3_f32 v20, v91, v92, v93
    v_max3_f32 v19, v19, v94, v95
    v_max3_f32 v19, v19, v20, v16
    s_waitcnt vmcnt(6)
    buffer_load_dwordx4 a[104:107], v2, s[40:43], s67 offen nt
    s_add_u32 s67, s67, s68
    v_mov_b32_dpp v19, v19 quad_perm:[0,0,0,0] row_mask:0xf bank_mask:0xf
    v_mov_b32 v20, v19
    s_nop 1
    v_permlane16_swap_b32 v19, v20
    v_max_f32 v19, v19, v20
    v_mov_b32 v20, v19
    s_nop 1
    v_permlane32_swap_b32 v19, v20
    v_max_f32 v19, v19, v20
    v_sub_f32 v18, v16, v19
    v_mul_f32 v18, 0x3fb8aa3b, v18
    v_exp_f32 v18, v18
    v_mov_b32 v16, v19
    v_mul_f32 v19, 0xbfb8aa3b, v19
    v_mul_f32 v17, v17, v18
    v_pk_mul_f32 v[12:13], v[12:13], v[18:19] op_sel_hi:[1,0]
    v_pk_mul_f32 v[14:15], v[14:15], v[18:19] op_sel_hi:[1,0]
    s_waitcnt vmcnt(6)
    buffer_load_dwordx4 a[108:111], v2, s[40:43], s67 offen nt
    s_add_u32 s67, s67, s68
    v_fmamk_f32 v64, v64, 0x3fb8aa3b, v19
    v_fmamk_f32 v65, v65, 0x3fb8aa3b, v19
    v_fmamk_f32 v66, v66, 0x3fb8aa3b, v19
    v_fmamk_f32 v67, v67, 0x3fb8aa3b, v19
    v_fmamk_f32 v68, v68, 0x3fb8aa3b, v19
    v_fmamk_f32 v69, v69, 0x3fb8aa3b, v19
    v_fmamk_f32 v70, v70, 0x3fb8aa3b, v19
    v_fmamk_f32 v71, v71, 0x3fb8aa3b, v19
    v_exp_f32_dpp v64, v64 quad_perm:[0,0,0,0] row_mask:0xf bank_mask:0xf
    v_exp_f32_dpp v65, v65 quad_perm:[0,0,0,0] row_mask:0xf bank_mask:0xf
    v_exp_f32_dpp v66, v66 quad_perm:[0,0,0,0] row_mask:0xf bank_mask:0xf
    v_exp_f32_dpp v67, v67 quad_perm:[0,0,0,0] row_mask:0xf bank_mask:0xf
    v_exp_f32_dpp v68, v68 quad_perm:[0,0,0,0] row_mask:0xf bank_mask:0xf
    v_exp_f32_dpp v69, v69 quad_perm:[0,0,0,0] row_mask:0xf bank_mask:0xf
    v_exp_f32_dpp v70, v70 quad_perm:[0,0,0,0] row_mask:0xf bank_mask:0xf
    v_exp_f32_dpp v71, v71 quad_perm:[0,0,0,0] row_mask:0xf bank_mask:0xf
    v_add_f32 v20, v64, v65
    v_add_f32 v21, v66, v67
    v_add_f32 v22, v68, v69
    v_add_f32 v23, v70, v71
    v_add_f32 v20, v20, v21
    v_add_f32 v22, v22, v23
    v_add_f32 v17, v17, v20
    v_add_f32 v17, v17, v22
    v_cvt_pk_bf16_f32 v64, v64, v64
    v_cvt_pk_bf16_f32 v65, v65, v65
    v_cvt_pk_bf16_f32 v66, v66, v66
    v_cvt_pk_bf16_f32 v67, v67, v67
    v_cvt_pk_bf16_f32 v68, v68, v68
    v_cvt_pk_bf16_f32 v69, v69, v69
    v_cvt_pk_bf16_f32 v70, v70, v70
    v_cvt_pk_bf16_f32 v71, v71, v71
    v_fmamk_f32 v72, v72, 0x3fb8aa3b, v19
    v_fmamk_f32 v73, v73, 0x3fb8aa3b, v19
    v_fmamk_f32 v74, v74, 0x3fb8aa3b, v19
    v_fmamk_f32 v75, v75, 0x3fb8aa3b, v19
    v_fmamk_f32 v76, v76, 0x3fb8aa3b, v19
    v_fmamk_f32 v77, v77, 0x3fb8aa3b, v19
    v_fmamk_f32 v78, v78, 0x3fb8aa3b, v19
    v_fmamk_f32 v79, v79, 0x3fb8aa3b, v19
    v_exp_f32_dpp v72, v72 quad_perm:[0,0,0,0] row_mask:0xf bank_mask:0xf
    v_exp_f32_dpp v73, v73 quad_perm:[0,0,0,0] row_mask:0xf bank_mask:0xf
    v_exp_f32_dpp v74, v74 quad_perm:[0,0,0,0] row_mask:0xf bank_mask:0xf
    v_exp_f32_dpp v75, v75 quad_perm:[0,0,0,0] row_mask:0xf bank_mask:0xf
    v_exp_f32_dpp v76, v76 quad_perm:[0,0,0,0] row_mask:0xf bank_mask:0xf
    v_exp_f32_dpp v77, v77 quad_perm:[0,0,0,0] row_mask:0xf bank_mask:0xf
    v_exp_f32_dpp v78, v78 quad_perm:[0,0,0,0] row_mask:0xf bank_mask:0xf
    v_exp_f32_dpp v79, v79 quad_perm:[0,0,0,0] row_mask:0xf bank_mask:0xf
    v_add_f32 v20, v72, v73
    v_add_f32 v21, v74, v75
    v_add_f32 v22, v76, v77
    v_add_f32 v23, v78, v79
    v_add_f32 v20, v20, v21
    v_add_f32 v22, v22, v23
    v_add_f32 v17, v17, v20
    v_add_f32 v17, v17, v22
    v_cvt_pk_bf16_f32 v72, v72, v72
    v_cvt_pk_bf16_f32 v73, v73, v73
    v_cvt_pk_bf16_f32 v74, v74, v74
    v_cvt_pk_bf16_f32 v75, v75, v75
    v_cvt_pk_bf16_f32 v76, v76, v76
    v_cvt_pk_bf16_f32 v77, v77, v77
    v_cvt_pk_bf16_f32 v78, v78, v78
    v_cvt_pk_bf16_f32 v79, v79, v79
    v_fmamk_f32 v80, v80, 0x3fb8aa3b, v19
    v_fmamk_f32 v81, v81, 0x3fb8aa3b, v19
    v_fmamk_f32 v82, v82, 0x3fb8aa3b, v19
    v_fmamk_f32 v83, v83, 0x3fb8aa3b, v19
    v_fmamk_f32 v84, v84, 0x3fb8aa3b, v19
    v_fmamk_f32 v85, v85, 0x3fb8aa3b, v19
    v_fmamk_f32 v86, v86, 0x3fb8aa3b, v19
    v_fmamk_f32 v87, v87, 0x3fb8aa3b, v19
    v_exp_f32_dpp v80, v80 quad_perm:[0,0,0,0] row_mask:0xf bank_mask:0xf
    v_exp_f32_dpp v81, v81 quad_perm:[0,0,0,0] row_mask:0xf bank_mask:0xf
    v_exp_f32_dpp v82, v82 quad_perm:[0,0,0,0] row_mask:0xf bank_mask:0xf
    v_exp_f32_dpp v83, v83 quad_perm:[0,0,0,0] row_mask:0xf bank_mask:0xf
    v_exp_f32_dpp v84, v84 quad_perm:[0,0,0,0] row_mask:0xf bank_mask:0xf
    v_exp_f32_dpp v85, v85 quad_perm:[0,0,0,0] row_mask:0xf bank_mask:0xf
    v_exp_f32_dpp v86, v86 quad_perm:[0,0,0,0] row_mask:0xf bank_mask:0xf
    v_exp_f32_dpp v87, v87 quad_perm:[0,0,0,0] row_mask:0xf bank_mask:0xf
    v_add_f32 v20, v80, v81
    v_add_f32 v21, v82, v83
    v_add_f32 v22, v84, v85
    v_add_f32 v23, v86, v87
    v_add_f32 v20, v20, v21
    v_add_f32 v22, v22, v23
    v_add_f32 v17, v17, v20
    v_add_f32 v17, v17, v22
    v_cvt_pk_bf16_f32 v80, v80, v80
    v_cvt_pk_bf16_f32 v81, v81, v81
    v_cvt_pk_bf16_f32 v82, v82, v82
    v_cvt_pk_bf16_f32 v83, v83, v83
    v_cvt_pk_bf16_f32 v84, v84, v84
    v_cvt_pk_bf16_f32 v85, v85, v85
    v_cvt_pk_bf16_f32 v86, v86, v86
    v_cvt_pk_bf16_f32 v87, v87, v87
    v_fmamk_f32 v88, v88, 0x3fb8aa3b, v19
    v_fmamk_f32 v89, v89, 0x3fb8aa3b, v19
    v_fmamk_f32 v90, v90, 0x3fb8aa3b, v19
    v_fmamk_f32 v91, v91, 0x3fb8aa3b, v19
    v_fmamk_f32 v92, v92, 0x3fb8aa3b, v19
    v_fmamk_f32 v93, v93, 0x3fb8aa3b, v19
    v_fmamk_f32 v94, v94, 0x3fb8aa3b, v19
    v_fmamk_f32 v95, v95, 0x3fb8aa3b, v19
    v_exp_f32_dpp v88, v88 quad_perm:[0,0,0,0] row_mask:0xf bank_mask:0xf
    v_exp_f32_dpp v89, v89 quad_perm:[0,0,0,0] row_mask:0xf bank_mask:0xf
    v_exp_f32_dpp v90, v90 quad_perm:[0,0,0,0] row_mask:0xf bank_mask:0xf
    v_exp_f32_dpp v91, v91 quad_perm:[0,0,0,0] row_mask:0xf bank_mask:0xf
    v_exp_f32_dpp v92, v92 quad_perm:[0,0,0,0] row_mask:0xf bank_mask:0xf
    v_exp_f32_dpp v93, v93 quad_perm:[0,0,0,0] row_mask:0xf bank_mask:0xf
    v_exp_f32_dpp v94, v94 quad_perm:[0,0,0,0] row_mask:0xf bank_mask:0xf
    v_exp_f32_dpp v95, v95 quad_perm:[0,0,0,0] row_mask:0xf bank_mask:0xf
    v_add_f32 v20, v88, v89
    v_add_f32 v21, v90, v91
    v_add_f32 v22, v92, v93
    v_add_f32 v23, v94, v95
    v_add_f32 v20, v20, v21
    v_add_f32 v22, v22, v23
    v_add_f32 v17, v17, v20
    v_add_f32 v17, v17, v22
    v_cvt_pk_bf16_f32 v88, v88, v88
    v_cvt_pk_bf16_f32 v89, v89, v89
    v_cvt_pk_bf16_f32 v90, v90, v90
    v_cvt_pk_bf16_f32 v91, v91, v91
    v_cvt_pk_bf16_f32 v92, v92, v92
    v_cvt_pk_bf16_f32 v93, v93, v93
    v_cvt_pk_bf16_f32 v94, v94, v94
    v_cvt_pk_bf16_f32 v95, v95, v95
    v_mov_b32 v19, v17
    s_nop 1
    v_permlane16_swap_b32 v17, v19
    v_add_f32 v17, v17, v19
    v_mov_b32 v19, v17
    s_nop 1
    v_permlane32_swap_b32 v17, v19
    v_add_f32 v17, v17, v19
    v_lshlrev_b32 v19, 3, v0
    s_lshl_b32 s63, s3, 9
    v_add_u32 v19, s63, v19
    ds_write_b64 v19, v[16:17] offset:9216
    v_mov_b32 v19, 0
    v_mov_b32 v20, 1
    s_mov_b64 exec, 1
    ds_add_u32 v19, v20 offset:16
    s_mov_b64 exec, -1
    v_and_b32 v24, v64, v8
    v_and_b32 v25, v64, v9
    v_and_b32 v26, v64, v10
    v_and_b32 v27, v64, v11
    v_and_b32 v28, v65, v8
    v_and_b32 v29, v65, v9
    v_and_b32 v30, v65, v10
    v_and_b32 v31, v65, v11
    s_waitcnt vmcnt(11)
    v_mfma_f32_16x16x32_bf16 v[12:15], a[64:67], v[24:27], v[12:15]
    s_waitcnt vmcnt(6)
    buffer_load_dwordx4 a[112:115], v2, s[40:43], s67 offen nt
    s_add_u32 s67, s67, s68
    v_and_b32 v24, v66, v8
    v_and_b32 v25, v66, v9
    v_and_b32 v26, v66, v10
    v_and_b32 v27, v66, v11
    s_waitcnt vmcnt(11)
    v_mfma_f32_16x16x32_bf16 v[12:15], a[68:71], v[28:31], v[12:15]
    s_waitcnt vmcnt(6)
    buffer_load_dwordx4 a[116:119], v2, s[40:43], s67 offen nt
    s_add_u32 s67, s67, s68
    v_and_b32 v28, v67, v8
    v_and_b32 v29, v67, v9
    v_and_b32 v30, v67, v10
    v_and_b32 v31, v67, v11
    s_waitcnt vmcnt(11)
    v_mfma_f32_16x16x32_bf16 v[12:15], a[72:75], v[24:27], v[12:15]
    s_waitcnt vmcnt(6)
    buffer_load_dwordx4 a[120:123], v2, s[40:43], s67 offen nt
    s_add_u32 s67, s67, s68
    v_and_b32 v24, v68, v8
    v_and_b32 v25, v68, v9
    v_and_b32 v26, v68, v10
    v_and_b32 v27, v68, v11
    s_waitcnt vmcnt(11)
    v_mfma_f32_16x16x32_bf16 v[12:15], a[76:79], v[28:31], v[12:15]
    s_waitcnt vmcnt(6)
    buffer_load_dwordx4 a[124:127], v2, s[40:43], s67 offen nt
    s_add_u32 s67, s67, s68
    v_and_b32 v28, v69, v8
    v_and_b32 v29, v69, v9
    v_and_b32 v30, v69, v10
    v_and_b32 v31, v69, v11
    s_waitcnt vmcnt(11)
    v_mfma_f32_16x16x32_bf16 v[12:15], a[80:83], v[24:27], v[12:15]
    s_waitcnt vmcnt(6)
    buffer_load_dwordx4 v[96:99], v2, s[40:43], s67 offen nt
    s_add_u32 s67, s67, s68
    v_and_b32 v24, v70, v8
    v_and_b32 v25, v70, v9
    v_and_b32 v26, v70, v10
    v_and_b32 v27, v70, v11
    s_waitcnt vmcnt(11)
    v_mfma_f32_16x16x32_bf16 v[12:15], a[84:87], v[28:31], v[12:15]
    s_waitcnt vmcnt(6)
    buffer_load_dwordx4 v[100:103], v2, s[40:43], s67 offen nt
    s_add_u32 s67, s67, s68
    v_and_b32 v28, v71, v8
    v_and_b32 v29, v71, v9
    v_and_b32 v30, v71, v10
    v_and_b32 v31, v71, v11
    s_waitcnt vmcnt(11)
    v_mfma_f32_16x16x32_bf16 v[12:15], a[88:91], v[24:27], v[12:15]
    s_waitcnt vmcnt(6)
    buffer_load_dwordx4 v[104:107], v2, s[40:43], s67 offen nt
    s_add_u32 s67, s67, s68
    s_waitcnt vmcnt(11)
    v_mfma_f32_16x16x32_bf16 v[12:15], a[92:95], v[28:31], v[12:15]
    s_waitcnt vmcnt(6)
    buffer_load_dwordx4 v[108:111], v2, s[40:43], s67 offen nt
    s_add_u32 s67, s67, s68
    v_and_b32 v24, v72, v8
    v_and_b32 v25, v72, v9
    v_and_b32 v26, v72, v10
    v_and_b32 v27, v72, v11
    v_and_b32 v28, v73, v8
    v_and_b32 v29, v73, v9
    v_and_b32 v30, v73, v10
    v_and_b32 v31, v73, v11
    s_waitcnt vmcnt(11)
    v_mfma_f32_16x16x32_bf16 v[12:15], a[96:99], v[24:27], v[12:15]
    s_waitcnt vmcnt(6)
    buffer_load_dwordx4 v[112:115], v2, s[40:43], s67 offen nt
    s_add_u32 s67, s67, s68
    v_and_b32 v24, v74, v8
    v_and_b32 v25, v74, v9
    v_and_b32 v26, v74, v10
    v_and_b32 v27, v74, v11
    s_waitcnt vmcnt(11)
    v_mfma_f32_16x16x32_bf16 v[12:15], a[100:103], v[28:31], v[12:15]
    s_waitcnt vmcnt(6)
    buffer_load_dwordx4 v[116:119], v2, s[40:43], s67 offen nt
    s_add_u32 s67, s67, s68
    v_and_b32 v28, v75, v8
    v_and_b32 v29, v75, v9
    v_and_b32 v30, v75, v10
    v_and_b32 v31, v75, v11
    s_waitcnt vmcnt(11)
    v_mfma_f32_16x16x32_bf16 v[12:15], a[104:107], v[24:27], v[12:15]
    s_waitcnt vmcnt(6)
    buffer_load_dwordx4 v[120:123], v2, s[40:43], s67 offen nt
    s_add_u32 s67, s67, s68
    v_and_b32 v24, v76, v8
    v_and_b32 v25, v76, v9
    v_and_b32 v26, v76, v10
    v_and_b32 v27, v76, v11
    s_waitcnt vmcnt(11)
    v_mfma_f32_16x16x32_bf16 v[12:15], a[108:111], v[28:31], v[12:15]
    s_waitcnt vmcnt(6)
    buffer_load_dwordx4 v[124:127], v2, s[40:43], s67 offen nt
    s_add_u32 s67, s67, s68
    v_and_b32 v28, v77, v8
    v_and_b32 v29, v77, v9
    v_and_b32 v30, v77, v10
    v_and_b32 v31, v77, v11
    s_waitcnt vmcnt(11)
    v_mfma_f32_16x16x32_bf16 v[12:15], a[112:115], v[24:27], v[12:15]
    s_waitcnt vmcnt(6)
    buffer_load_dwordx4 a[0:3], v2, s[40:43], s67 offen nt
    s_add_u32 s67, s67, s68
    v_and_b32 v24, v78, v8
    v_and_b32 v25, v78, v9
    v_and_b32 v26, v78, v10
    v_and_b32 v27, v78, v11
    s_waitcnt vmcnt(11)
    v_mfma_f32_16x16x32_bf16 v[12:15], a[116:119], v[28:31], v[12:15]
    s_waitcnt vmcnt(6)
    buffer_load_dwordx4 a[4:7], v2, s[40:43], s67 offen nt
    s_add_u32 s67, s67, s68
    v_and_b32 v28, v79, v8
    v_and_b32 v29, v79, v9
    v_and_b32 v30, v79, v10
    v_and_b32 v31, v79, v11
    s_waitcnt vmcnt(11)
    v_mfma_f32_16x16x32_bf16 v[12:15], a[120:123], v[24:27], v[12:15]
    s_waitcnt vmcnt(6)
    buffer_load_dwordx4 a[8:11], v2, s[40:43], s67 offen nt
    s_add_u32 s67, s67, s68
    s_waitcnt vmcnt(11)
    v_mfma_f32_16x16x32_bf16 v[12:15], a[124:127], v[28:31], v[12:15]
    s_waitcnt vmcnt(6)
    buffer_load_dwordx4 a[12:15], v2, s[40:43], s67 offen nt
    s_add_u32 s67, s67, s68
    v_and_b32 v24, v80, v8
    v_and_b32 v25, v80, v9
    v_and_b32 v26, v80, v10
    v_and_b32 v27, v80, v11
    v_and_b32 v28, v81, v8
    v_and_b32 v29, v81, v9
    v_and_b32 v30, v81, v10
    v_and_b32 v31, v81, v11
    s_waitcnt vmcnt(11)
    v_mfma_f32_16x16x32_bf16 v[12:15], v[96:99], v[24:27], v[12:15]
    s_waitcnt vmcnt(6)
    buffer_load_dwordx4 a[16:19], v2, s[40:43], s67 offen nt
    s_add_u32 s67, s67, s68
    v_and_b32 v24, v82, v8
    v_and_b32 v25, v82, v9
    v_and_b32 v26, v82, v10
    v_and_b32 v27, v82, v11
    s_waitcnt vmcnt(11)
    v_mfma_f32_16x16x32_bf16 v[12:15], v[100:103], v[28:31], v[12:15]
    s_waitcnt vmcnt(6)
    buffer_load_dwordx4 a[20:23], v2, s[40:43], s67 offen nt
    s_add_u32 s67, s67, s68
    v_and_b32 v28, v83, v8
    v_and_b32 v29, v83, v9
    v_and_b32 v30, v83, v10
    v_and_b32 v31, v83, v11
    s_waitcnt vmcnt(11)
    v_mfma_f32_16x16x32_bf16 v[12:15], v[104:107], v[24:27], v[12:15]
    s_waitcnt vmcnt(6)
    buffer_load_dwordx4 a[24:27], v2, s[40:43], s67 offen nt
    s_add_u32 s67, s67, s68
    v_mov_b32 v3, 8
    s_mov_b64 exec, 1
    ds_add_u32 v3, v3
    s_mov_b64 exec, -1
    v_and_b32 v24, v84, v8
    v_and_b32 v25, v84, v9
    v_and_b32 v26, v84, v10
    v_and_b32 v27, v84, v11
    s_waitcnt vmcnt(11)
    v_mfma_f32_16x16x32_bf16 v[12:15], v[108:111], v[28:31], v[12:15]
    s_waitcnt vmcnt(6)
    buffer_load_dwordx4 a[28:31], v2, s[40:43], s67 offen nt
    s_add_u32 s67, s67, s68
    v_and_b32 v28, v85, v8
    v_and_b32 v29, v85, v9
    v_and_b32 v30, v85, v10
    v_and_b32 v31, v85, v11
    s_waitcnt vmcnt(11)
    v_mfma_f32_16x16x32_bf16 v[12:15], v[112:115], v[24:27], v[12:15]
    v_and_b32 v24, v86, v8
    v_and_b32 v25, v86, v9
    v_and_b32 v26, v86, v10
    v_and_b32 v27, v86, v11
    s_waitcnt vmcnt(10)
    v_mfma_f32_16x16x32_bf16 v[12:15], v[116:119], v[28:31], v[12:15]
    v_and_b32 v28, v87, v8
    v_and_b32 v29, v87, v9
    v_and_b32 v30, v87, v10
    v_and_b32 v31, v87, v11
    s_waitcnt vmcnt(9)
    v_mfma_f32_16x16x32_bf16 v[12:15], v[120:123], v[24:27], v[12:15]
    s_waitcnt vmcnt(8)
    v_mfma_f32_16x16x32_bf16 v[12:15], v[124:127], v[28:31], v[12:15]
    s_bfe_u32 s57, s56, 0x80000
    s_bfe_u32 s58, s56, 0x80008
    s_bfe_u32 s59, s56, 0x80010
    s_bfe_u32 s60, s56, 0x80018
    v_mov_b32 v18, 0xffffff00
    v_lshrrev_b32 v1, 4, v0
    v_bfe_u32 v20, v0, 3, 1
    v_lshl_add_u32 v1, v20, 2, v1
    v_lshlrev_b32 v1, 7, v1
    v_and_b32 v20, 7, v0
    v_lshl_add_u32 v1, v20, 4, v1
    s_lshl_b32 s63, s34, 10
    s_add_u32 s63, s63, 524288
    v_add_u32 v1, s63, v1
    v_lshlrev_b32 v2, 4, v0
    s_lshl_b32 s63, s3, 10
    v_add_u32 v23, s63, v2
    v_mov_b32 v21, 0
    v_mov_b32 v22, 1
    s_mov_b32 s65, 0
    v_and_b32 v24, v88, v8
    v_and_b32 v25, v88, v9
    v_and_b32 v26, v88, v10
    v_and_b32 v27, v88, v11
    v_and_b32 v28, v89, v8
    v_and_b32 v29, v89, v9
    v_and_b32 v30, v89, v10
    v_and_b32 v31, v89, v11
    s_waitcnt vmcnt(7)
    v_mfma_f32_16x16x32_bf16 v[12:15], a[0:3], v[24:27], v[12:15]
    v_and_b32 v24, v90, v8
    v_and_b32 v25, v90, v9
    v_and_b32 v26, v90, v10
    v_and_b32 v27, v90, v11
    s_waitcnt vmcnt(6)
    v_mfma_f32_16x16x32_bf16 v[12:15], a[4:7], v[28:31], v[12:15]
    v_and_b32 v28, v91, v8
    v_and_b32 v29, v91, v9
    v_and_b32 v30, v91, v10
    v_and_b32 v31, v91, v11
    s_waitcnt vmcnt(5)
    v_mfma_f32_16x16x32_bf16 v[12:15], a[8:11], v[24:27], v[12:15]
    v_and_b32 v24, v92, v8
    v_and_b32 v25, v92, v9
    v_and_b32 v26, v92, v10
    v_and_b32 v27, v92, v11
    s_waitcnt vmcnt(4)
    v_mfma_f32_16x16x32_bf16 v[12:15], a[12:15], v[28:31], v[12:15]
    v_and_b32 v28, v93, v8
    v_and_b32 v29, v93, v9
    v_and_b32 v30, v93, v10
    v_and_b32 v31, v93, v11
    s_waitcnt vmcnt(3)
    v_mfma_f32_16x16x32_bf16 v[12:15], a[16:19], v[24:27], v[12:15]
    v_and_b32 v24, v94, v8
    v_and_b32 v25, v94, v9
    v_and_b32 v26, v94, v10
    v_and_b32 v27, v94, v11
    s_waitcnt vmcnt(2)
    v_mfma_f32_16x16x32_bf16 v[12:15], a[20:23], v[28:31], v[12:15]
    v_and_b32 v28, v95, v8
    v_and_b32 v29, v95, v9
    v_and_b32 v30, v95, v10
    v_and_b32 v31, v95, v11
    s_waitcnt vmcnt(1)
    v_mfma_f32_16x16x32_bf16 v[12:15], a[24:27], v[24:27], v[12:15]
    s_waitcnt vmcnt(0)
    v_mfma_f32_16x16x32_bf16 v[12:15], a[28:31], v[28:31], v[12:15]
    s_cmp_eq_u32 s3, 0
    s_cbranch_scc1 L_s_red
    s_nop 5
    ds_write_b128 v23, v[12:15] offset:5120
    s_mov_b64 exec, 1
    ds_add_u32 v21, v22 offset:20
    s_mov_b64 exec, -1
    s_branch L_s_done
L_s_red:
    ds_read_b32 v39, v21 offset:20
    ds_read_b128 v[40:43], v2 offset:15360
    ds_read_b128 v[44:47], v2 offset:6144
    ds_read_b128 v[48:51], v2 offset:7168
    ds_read_b128 v[52:55], v2 offset:8192
    s_add_u32 s65, s65, 1
    s_cmp_gt_u32 s65, 400000
    s_cbranch_scc1 L_end
    s_waitcnt lgkmcnt(4)
    v_cmp_ne_u32 vcc, 4, v39
    s_cbranch_vccnz L_s_red
    s_waitcnt lgkmcnt(3)
    v_pk_mul_f32 v[12:13], v[12:13], v[40:41] op_sel_hi:[1,0]
    v_pk_mul_f32 v[14:15], v[14:15], v[40:41] op_sel_hi:[1,0]
    s_waitcnt lgkmcnt(2)
    v_pk_fma_f32 v[12:13], v[44:45], v[40:41], v[12:13] op_sel:[0,1,0] op_sel_hi:[1,1,1]
    v_pk_fma_f32 v[14:15], v[46:47], v[40:41], v[14:15] op_sel:[0,1,0] op_sel_hi:[1,1,1]
    s_waitcnt lgkmcnt(1)
    v_pk_fma_f32 v[12:13], v[48:49], v[42:43], v[12:13] op_sel:[0,0,0] op_sel_hi:[1,0,1]
    v_pk_fma_f32 v[14:15], v[50:51], v[42:43], v[14:15] op_sel:[0,0,0] op_sel_hi:[1,0,1]
    s_waitcnt lgkmcnt(0)
    v_pk_fma_f32 v[12:13], v[52:53], v[42:43], v[12:13] op_sel:[0,1,0] op_sel_hi:[1,1,1]
    v_pk_fma_f32 v[14:15], v[54:55], v[42:43], v[14:15] op_sel:[0,1,0] op_sel_hi:[1,1,1]
    v_and_or_b32 v12, v12, v18, s57
    v_and_or_b32 v13, v13, v18, s58
    v_and_or_b32 v14, v14, v18, s59
    v_and_or_b32 v15, v15, v18, s60
    s_cmp_eq_u32 s69, 0
    s_cbranch_scc1 L_sl3
    buffer_store_dwordx4 v[12:15], v1, s[44:47], 0 offen
    s_branch L_sd4
L_sl3:
    buffer_store_dwordx4 v[12:15], v1, s[44:47], 0 offen sc1
L_sd4:
L_s_done:
    s_cmp_eq_u32 s2, 8
    s_cbranch_scc1 L_fin
    s_cmp_eq_u32 s2, 76
    s_cbranch_scc1 L_fin
    s_endpgm
L_fin:
    s_add_u32 s68, s3, 4
    s_mul_i32 s63, s31, 1152
    s_add_u32 s48, s4, s63
    s_addc_u32 s49, s5, 0
    s_and_b32 s49, s49, 0xffff
    s_mov_b32 s50, 1152
    s_mov_b32 s51, 0x20000
    s_add_u32 s52, s24, s63
    s_addc_u32 s53, s25, 0
    s_and_b32 s53, s53, 0xffff
    s_mov_b32 s54, 1152
    s_mov_b32 s55, 0x20000
    v_and_b32 v38, 15, v0
    v_lshrrev_b32 v36, 4, v0
    v_lshl_add_u32 v38, v38, 2, v36
    v_lshlrev_b32 v38, 1, v38
    s_lshl_b32 s63, s3, 7
    v_add_u32 v36, s63, v38
    s_lshl_b32 s63, s68, 7
    v_add_u32 v35, s63, v38
    buffer_load_ushort v32, v36, s[48:51], 0 offen
    buffer_load_ushort v33, v35, s[48:51], 0 offen
    s_mul_i32 s64, s31, 9
    s_add_u32 s66, s64, s3
    s_lshl_b32 s66, s66, 12
    s_add_u32 s66, s66, 917504
    s_add_u32 s67, s64, s68
    s_lshl_b32 s67, s67, 12
    s_add_u32 s67, s67, 917504
    v_lshlrev_b32 v34, 4, v0
    v_lshlrev_b32 v19, 2, v0
    v_add_u32 v19, 18432, v19
    s_lshl_b32 s63, s3, 8
    s_sub_u32 s63, s63, 2048
    v_add_u32 v39, s63, v19
    v_add_u32 v37, 1024, v38
    s_cmp_eq_u32 s3, 3
    s_cselect_b32 s63, 0, 0x10000
    v_add_u32 v37, s63, v37
    v_mov_b32 v21, 0x3f803f80
    v_mov_b32 v22, 0x3ae38e39
    v_mov_b32 v23, 0x3ae38e39
    s_mov_b32 s94, 0x00010001
    s_mov_b32 s95, 0x6e006e00
    s_mov_b32 s65, 0
    v_mov_b32 v17, 0
L_lw5:
    ds_read_b32 v16, v17 offset:32
    s_waitcnt lgkmcnt(0)
    v_readfirstlane_b32 s63, v16
    s_cmp_ge_u32 s63, 4
    s_cbranch_scc1 L_lwd6
    s_add_u32 s65, s65, 1
    s_cmp_gt_u32 s65, 400000
    s_cbranch_scc1 L_end
    s_sleep 1
    s_branch L_lw5
L_lwd6:
    s_waitcnt vmcnt(0)
    v_lshlrev_b32 v32, 16, v32
    v_lshlrev_b32 v33, 16, v33
    s_mov_b32 s65, 0
L_pl7:
    buffer_load_dwordx4 v[40:43], v34, s[44:47], s66 offen offset:0 sc1
    buffer_load_dwordx4 v[44:47], v34, s[44:47], s66 offen offset:1024 sc1
    buffer_load_dwordx4 v[48:51], v34, s[44:47], s66 offen offset:2048 sc1
    buffer_load_dwordx4 v[52:55], v34, s[44:47], s66 offen offset:3072 sc1
    buffer_load_dwordx4 v[56:59], v34, s[44:47], s67 offen offset:0 sc1
    buffer_load_dwordx4 v[60:63], v34, s[44:47], s67 offen offset:1024 sc1
    buffer_load_dwordx4 v[64:67], v34, s[44:47], s67 offen offset:2048 sc1
    buffer_load_dwordx4 v[68:71], v34, s[44:47], s67 offen offset:3072 sc1
    s_add_u32 s65, s65, 1
    s_cmp_gt_u32 s65, 20000
    s_cbranch_scc1 L_end
    s_waitcnt vmcnt(0)
    v_xor_b32 v40, s57, v40
    v_xor_b32 v41, s58, v41
    v_xor_b32 v42, s59, v42
    v_xor_b32 v43, s60, v43
    v_or3_b32 v6, v40, v41, v42
    v_or_b32 v6, v6, v43
    v_xor_b32 v44, s57, v44
    v_xor_b32 v45, s58, v45
    v_xor_b32 v46, s59, v46
    v_xor_b32 v47, s60, v47
    v_or3_b32 v6, v6, v44, v45
    v_or3_b32 v6, v6, v46, v47
    v_xor_b32 v48, s57, v48
    v_xor_b32 v49, s58, v49
    v_xor_b32 v50, s59, v50
    v_xor_b32 v51, s60, v51
    v_or3_b32 v6, v6, v48, v49
    v_or3_b32 v6, v6, v50, v51
    v_xor_b32 v52, s57, v52
    v_xor_b32 v53, s58, v53
    v_xor_b32 v54, s59, v54
    v_xor_b32 v55, s60, v55
    v_or3_b32 v6, v6, v52, v53
    v_or3_b32 v6, v6, v54, v55
    v_xor_b32 v56, s57, v56
    v_xor_b32 v57, s58, v57
    v_xor_b32 v58, s59, v58
    v_xor_b32 v59, s60, v59
    v_or3_b32 v6, v6, v56, v57
    v_or3_b32 v6, v6, v58, v59
    v_xor_b32 v60, s57, v60
    v_xor_b32 v61, s58, v61
    v_xor_b32 v62, s59, v62
    v_xor_b32 v63, s60, v63
    v_or3_b32 v6, v6, v60, v61
    v_or3_b32 v6, v6, v62, v63
    v_xor_b32 v64, s57, v64
    v_xor_b32 v65, s58, v65
    v_xor_b32 v66, s59, v66
    v_xor_b32 v67, s60, v67
    v_or3_b32 v6, v6, v64, v65
    v_or3_b32 v6, v6, v66, v67
    v_xor_b32 v68, s57, v68
    v_xor_b32 v69, s58, v69
    v_xor_b32 v70, s59, v70
    v_xor_b32 v71, s60, v71
    v_or3_b32 v6, v6, v68, v69
    v_or3_b32 v6, v6, v70, v71
    v_and_b32 v6, 0xff, v6
    v_cmp_ne_u32 vcc, 0, v6
    s_cbranch_vccz L_pld8
    s_mov_b64 exec, vcc
    s_branch L_pl7
L_pld8:
    s_mov_b64 exec, -1
    s_nop 0
    v_pk_add_f32 v[40:41], v[40:41], v[44:45]
    v_pk_add_f32 v[48:49], v[48:49], v[52:53]
    v_pk_add_f32 v[42:43], v[42:43], v[46:47]
    v_pk_add_f32 v[50:51], v[50:51], v[54:55]
    v_pk_add_f32 v[56:57], v[56:57], v[60:61]
    v_pk_add_f32 v[64:65], v[64:65], v[68:69]
    v_pk_add_f32 v[58:59], v[58:59], v[62:63]
    v_pk_add_f32 v[66:67], v[66:67], v[70:71]
    v_pk_add_f32 v[40:41], v[40:41], v[48:49]
    v_pk_add_f32 v[42:43], v[42:43], v[50:51]
    v_pk_add_f32 v[56:57], v[56:57], v[64:65]
    v_pk_add_f32 v[58:59], v[58:59], v[66:67]
    v_permlane32_swap_b32 v40, v42
    v_permlane32_swap_b32 v41, v43
    v_permlane32_swap_b32 v56, v58
    v_permlane32_swap_b32 v57, v59
    v_pk_add_f32 v[40:41], v[40:41], v[42:43]
    v_pk_add_f32 v[56:57], v[56:57], v[58:59]
    s_nop 0
    v_permlane16_swap_b32 v40, v41
    v_permlane16_swap_b32 v56, v57
    v_add_f32 v4, v40, v41
    v_add_f32 v5, v56, v57
    v_cvt_pk_bf16_f32 v6, v4, v5
    v_and_b32 v5, 0xffff0000, v6
    v_lshlrev_b32 v4, 16, v6
    v_pk_add_f32 v[4:5], v[4:5], v[32:33]
    v_cvt_pk_bf16_f32 v24, v4, v5
    ds_write2st64_b32 v39, v24, v24 offset0:0 offset1:4
    v_and_b32 v9, 0xffff0000, v24
    v_lshlrev_b32 v8, 16, v24
    v_dot2_f32_bf16 v12, v24, v21, 0
    v_dot2_f32_bf16 v13, v24, v24, 0
    s_waitcnt lgkmcnt(0)
    s_barrier
    ds_read2st64_b32 v[26:27], v39 offset0:1 offset1:2
    ds_read_b32 v28, v39 offset:768
    ds_read_b32 v25, v19
    s_waitcnt lgkmcnt(2)
    v_dot2_f32_bf16 v12, v26, v21, v12
    v_dot2_f32_bf16 v13, v26, v26, v13
    v_dot2_f32_bf16 v12, v27, v21, v12
    v_dot2_f32_bf16 v13, v27, v27, v13
    s_waitcnt lgkmcnt(0)
    v_dot2_f32_bf16 v12, v28, v21, v12
    v_dot2_f32_bf16 v13, v28, v28, v13
    v_dot2_f32_bf16 v12, v25, v21, v12
    v_dot2_f32_bf16 v13, v25, v25, v13
    v_and_b32 v45, 0xffff0000, v26
    v_lshlrev_b32 v44, 16, v26
    v_and_b32 v47, 0xffff0000, v27
    v_add_f32_dpp v12, v12, v12 quad_perm:[1,0,3,2] row_mask:0xf bank_mask:0xf
    v_add_f32_dpp v13, v13, v13 quad_perm:[1,0,3,2] row_mask:0xf bank_mask:0xf
    v_lshlrev_b32 v46, 16, v27
    v_add_f32_dpp v12, v12, v12 quad_perm:[2,3,0,1] row_mask:0xf bank_mask:0xf
    v_add_f32_dpp v13, v13, v13 quad_perm:[2,3,0,1] row_mask:0xf bank_mask:0xf
    v_and_b32 v49, 0xffff0000, v28
    v_add_f32_dpp v12, v12, v12 row_half_mirror row_mask:0xf bank_mask:0xf
    v_add_f32_dpp v13, v13, v13 row_half_mirror row_mask:0xf bank_mask:0xf
    v_lshlrev_b32 v48, 16, v28
    v_add_f32_dpp v12, v12, v12 row_mirror row_mask:0xf bank_mask:0xf
    v_add_f32_dpp v13, v13, v13 row_mirror row_mask:0xf bank_mask:0xf
    v_lshlrev_b32 v20, 16, v25
    v_add_f32_dpp v12, v12, v12 row_bcast:15 row_mask:0xa bank_mask:0xf
    v_add_f32_dpp v13, v13, v13 row_bcast:15 row_mask:0xa bank_mask:0xf
    s_nop 0
    v_add_f32_dpp v12, v12, v12 row_bcast:31 row_mask:0xc bank_mask:0xf
    v_add_f32_dpp v13, v13, v13 row_bcast:31 row_mask:0xc bank_mask:0xf
    v_readlane_b32 s92, v12, 63
    v_readlane_b32 s93, v13, 63
    s_nop 1
    v_pk_mul_f32 v[12:13], v[22:23], s[92:93]
    v_fma_f32 v13, -v12, v12, v13
    v_max_f32 v13, 0, v13
    v_cvt_pk_bf16_f32 v14, v12, v13
    v_lshlrev_b32 v12, 16, v14
    v_and_b32 v16, 0xffff0000, v14
    v_add_f32 v16, 0x3727c5ac, v16
    v_pk_add_f32 v[40:41], v[8:9], v[12:13] op_sel_hi:[1,0] neg_lo:[0,1] neg_hi:[0,1]
    v_cvt_pk_bf16_f32 v16, v16, v16
    v_sub_f32 v42, v20, v12
    v_pk_add_f32 v[44:45], v[44:45], v[12:13] op_sel_hi:[1,0] neg_lo:[0,1] neg_hi:[0,1]
    v_pk_add_f32 v[46:47], v[46:47], v[12:13] op_sel_hi:[1,0] neg_lo:[0,1] neg_hi:[0,1]
    v_pk_add_f32 v[48:49], v[48:49], v[12:13] op_sel_hi:[1,0] neg_lo:[0,1] neg_hi:[0,1]
    v_and_b32 v16, 0xffff0000, v16
    v_sqrt_f32_e64 v16, v16
    v_cvt_pk_bf16_f32 v24, v40, v41
    v_cvt_pk_bf16_f32 v25, v42, v42
    v_cvt_pk_bf16_f32 v26, v44, v45
    v_cvt_pk_bf16_f32 v27, v46, v47
    v_cvt_pk_bf16_f32 v28, v48, v49
    v_cvt_pk_bf16_f32 v16, v16, v16
    v_and_b32 v41, 0xffff0000, v24
    v_lshlrev_b32 v40, 16, v24
    v_and_b32 v16, 0xffff0000, v16
    v_rcp_f32 v16, v16
    v_lshlrev_b32 v42, 16, v25
    v_and_b32 v45, 0xffff0000, v26
    v_lshlrev_b32 v44, 16, v26
    v_and_b32 v47, 0xffff0000, v27
    v_lshlrev_b32 v46, 16, v27
    v_and_b32 v49, 0xffff0000, v28
    v_lshlrev_b32 v48, 16, v28
    v_pk_mul_f32 v[40:41], v[40:41], v[16:17] op_sel_hi:[1,0]
    v_mul_f32_e64 v42, v42, v16
    v_pk_mul_f32 v[44:45], v[44:45], v[16:17] op_sel_hi:[1,0]
    v_pk_mul_f32 v[46:47], v[46:47], v[16:17] op_sel_hi:[1,0]
    v_pk_mul_f32 v[48:49], v[48:49], v[16:17] op_sel_hi:[1,0]
    v_cvt_pk_bf16_f32 v24, v40, v41
    v_cvt_pk_bf16_f32 v25, v42, 0
    v_cvt_pk_bf16_f32 v26, v44, v45
    v_cvt_pk_bf16_f32 v27, v46, v47
    v_cvt_pk_bf16_f32 v28, v48, v49
    v_dot2_f32_bf16 v12, v24, v21, 0
    v_dot2_f32_bf16 v13, v24, v24, 0
    v_dot2_f32_bf16 v12, v25, v21, v12
    v_dot2_f32_bf16 v13, v25, v25, v13
    v_dot2_f32_bf16 v12, v26, v21, v12
    v_dot2_f32_bf16 v13, v26, v26, v13
    v_dot2_f32_bf16 v12, v27, v21, v12
    v_dot2_f32_bf16 v13, v27, v27, v13
    v_dot2_f32_bf16 v12, v28, v21, v12
    v_dot2_f32_bf16 v13, v28, v28, v13
    v_and_b32 v11, 0xffff0000, v24
    v_lshlrev_b32 v10, 16, v24
    v_lshlrev_b32 v42, 16, v25
    v_add_f32_dpp v12, v12, v12 quad_perm:[1,0,3,2] row_mask:0xf bank_mask:0xf
    v_add_f32_dpp v13, v13, v13 quad_perm:[1,0,3,2] row_mask:0xf bank_mask:0xf
    s_nop 0
    v_add_f32_dpp v12, v12, v12 quad_perm:[2,3,0,1] row_mask:0xf bank_mask:0xf
    v_add_f32_dpp v13, v13, v13 quad_perm:[2,3,0,1] row_mask:0xf bank_mask:0xf
    s_nop 0
    v_add_f32_dpp v12, v12, v12 row_half_mirror row_mask:0xf bank_mask:0xf
    v_add_f32_dpp v13, v13, v13 row_half_mirror row_mask:0xf bank_mask:0xf
    s_nop 0
    v_add_f32_dpp v12, v12, v12 row_mirror row_mask:0xf bank_mask:0xf
    v_add_f32_dpp v13, v13, v13 row_mirror row_mask:0xf bank_mask:0xf
    s_nop 0
    v_add_f32_dpp v12, v12, v12 row_bcast:15 row_mask:0xa bank_mask:0xf
    v_add_f32_dpp v13, v13, v13 row_bcast:15 row_mask:0xa bank_mask:0xf
    s_nop 0
    v_add_f32_dpp v12, v12, v12 row_bcast:31 row_mask:0xc bank_mask:0xf
    v_add_f32_dpp v13, v13, v13 row_bcast:31 row_mask:0xc bank_mask:0xf
    v_readlane_b32 s92, v12, 63
    v_readlane_b32 s93, v13, 63
    s_nop 1
    v_pk_mul_f32 v[12:13], v[22:23], s[92:93]
    v_fma_f32 v13, -v12, v12, v13
    v_max_f32 v13, 0, v13
    v_cvt_pk_bf16_f32 v14, v12, v13
    v_lshlrev_b32 v12, 16, v14
    v_and_b32 v16, 0xffff0000, v14
    v_add_f32 v16, 0x3727c5ac, v16
    v_pk_add_f32 v[4:5], v[10:11], v[12:13] op_sel_hi:[1,0] neg_lo:[0,1] neg_hi:[0,1]
    v_cvt_pk_bf16_f32 v16, v16, v16
    v_sub_f32 v42, v42, v12
    v_cvt_pk_bf16_f32 v6, v4, v5
    v_and_b32 v16, 0xffff0000, v16
    v_sqrt_f32 v16, v16
    v_cvt_pk_bf16_f32 v7, v42, v42
    v_and_b32 v5, 0xffff0000, v6
    v_lshlrev_b32 v4, 16, v6
    v_cvt_pk_bf16_f32 v16, v16, v16
    v_and_b32 v16, 0xffff0000, v16
    v_rcp_f32 v16, v16
    v_lshlrev_b32 v42, 16, v7
    v_pk_mul_f32 v[4:5], v[4:5], v[16:17] op_sel_hi:[1,0]
    v_mul_f32 v42, v42, v16
    v_cvt_pk_bf16_f32 v6, v4, v5
    v_cvt_pk_bf16_f32 v7, v42, v42
    v_lshlrev_b32 v12, 1, v6
    v_lshrrev_b32 v13, 15, v6
    v_lshlrev_b32 v26, 1, v7
    v_lshrrev_b32 v27, 15, v7
    v_bfi_b32 v12, s94, v13, v12
    v_bfi_b32 v26, s94, v27, v26
    v_pk_sub_u16 v12, v12, s95
    v_pk_sub_u16 v26, v26, s95
    v_lshlrev_b32_sdwa v14, 2, v12 dst_sel:DWORD dst_unused:UNUSED_PAD src0_sel:DWORD src1_sel:WORD_0
    ds_read_b32 v24, v14 offset:20480
    v_lshlrev_b32_sdwa v15, 2, v12 dst_sel:DWORD dst_unused:UNUSED_PAD src0_sel:DWORD src1_sel:WORD_1
    ds_read_b32 v25, v15 offset:20480
    v_lshlrev_b32_sdwa v16, 2, v26 dst_sel:DWORD dst_unused:UNUSED_PAD src0_sel:DWORD src1_sel:WORD_0
    ds_read_b32 v26, v16 offset:20480
    v_max3_u32 v13, v14, v15, v16
    v_cmp_le_u32 vcc, 20480, v13
    s_cbranch_vccnz L_direct
L_fin_out:
    s_waitcnt lgkmcnt(1)
    v_pk_add_f32 v[24:25], v[24:25], v[8:9]
    v_cvt_pk_bf16_f32 v24, v24, v25
    buffer_store_short v24, v36, s[52:55], 0 offen nt
    buffer_store_short_d16_hi v24, v35, s[52:55], 0 offen nt
    s_waitcnt lgkmcnt(0)
    v_add_f32 v26, v26, v20
    v_cvt_pk_bf16_f32 v26, v26, v26
    buffer_store_short v26, v37, s[52:55], 0 offen nt
L_fin_done:
    s_endpgm
L_fin_h2:
    s_mov_b32 s65, 0
    v_mov_b32 v17, 0
L_lw9:
    ds_read_b32 v16, v17 offset:32
    s_waitcnt lgkmcnt(0)
    v_readfirstlane_b32 s63, v16
    s_cmp_ge_u32 s63, 4
    s_cbranch_scc1 L_lwd10
    s_add_u32 s65, s65, 1
    s_cmp_gt_u32 s65, 400000
    s_cbranch_scc1 L_end
    s_sleep 1
    s_branch L_lw9
L_lwd10:
    s_cmp_lg_u32 s31, 0
    s_cbranch_scc1 L_ep_done
    s_mov_b64 exec, 1
    v_mov_b32 v2, 0
    v_mov_b32 v3, s56
    buffer_store_dword v3, v2, s[44:47], 0 offen
    s_mov_b64 exec, -1
L_ep_done:
    s_mov_b32 s68, 8
    s_mul_i32 s63, s31, 1152
    s_add_u32 s48, s4, s63
    s_addc_u32 s49, s5, 0
    s_and_b32 s49, s49, 0xffff
    s_mov_b32 s50, 1152
    s_mov_b32 s51, 0x20000
    s_add_u32 s52, s24, s63
    s_addc_u32 s53, s25, 0
    s_and_b32 s53, s53, 0xffff
    s_mov_b32 s54, 1152
    s_mov_b32 s55, 0x20000
    v_and_b32 v38, 15, v0
    v_lshrrev_b32 v36, 4, v0
    v_lshl_add_u32 v38, v38, 2, v36
    v_lshlrev_b32 v38, 1, v38
    s_lshl_b32 s63, s68, 7
    v_add_u32 v36, s63, v38
    v_mov_b32 v35, 0x10000
    buffer_load_ushort v32, v36, s[48:51], 0 offen
    buffer_load_ushort v33, v35, s[48:51], 0 offen
    s_mul_i32 s64, s31, 9
    s_add_u32 s66, s64, s68
    s_lshl_b32 s66, s66, 12
    s_add_u32 s66, s66, 917504
    v_lshlrev_b32 v34, 4, v0
    v_lshlrev_b32 v19, 2, v0
    v_add_u32 v19, 18432, v19
    s_waitcnt vmcnt(0)
    v_lshlrev_b32 v32, 16, v32
    v_lshlrev_b32 v33, 16, v33
    s_mov_b32 s65, 0
L_pl11:
    buffer_load_dwordx4 v[40:43], v34, s[44:47], s66 offen offset:0 sc1
    buffer_load_dwordx4 v[44:47], v34, s[44:47], s66 offen offset:1024 sc1
    buffer_load_dwordx4 v[48:51], v34, s[44:47], s66 offen offset:2048 sc1
    buffer_load_dwordx4 v[52:55], v34, s[44:47], s66 offen offset:3072 sc1
    s_add_u32 s65, s65, 1
    s_cmp_gt_u32 s65, 20000
    s_cbranch_scc1 L_end
    s_waitcnt vmcnt(0)
    v_xor_b32 v40, s57, v40
    v_xor_b32 v41, s58, v41
    v_xor_b32 v42, s59, v42
    v_xor_b32 v43, s60, v43
    v_or3_b32 v6, v40, v41, v42
    v_or_b32 v6, v6, v43
    v_xor_b32 v44, s57, v44
    v_xor_b32 v45, s58, v45
    v_xor_b32 v46, s59, v46
    v_xor_b32 v47, s60, v47
    v_or3_b32 v6, v6, v44, v45
    v_or3_b32 v6, v6, v46, v47
    v_xor_b32 v48, s57, v48
    v_xor_b32 v49, s58, v49
    v_xor_b32 v50, s59, v50
    v_xor_b32 v51, s60, v51
    v_or3_b32 v6, v6, v48, v49
    v_or3_b32 v6, v6, v50, v51
    v_xor_b32 v52, s57, v52
    v_xor_b32 v53, s58, v53
    v_xor_b32 v54, s59, v54
    v_xor_b32 v55, s60, v55
    v_or3_b32 v6, v6, v52, v53
    v_or3_b32 v6, v6, v54, v55
    v_and_b32 v6, 0xff, v6
    v_cmp_ne_u32 vcc, 0, v6
    s_cbranch_vccz L_pld12
    s_mov_b64 exec, vcc
    s_branch L_pl11
L_pld12:
    s_mov_b64 exec, -1
    s_nop 0
    v_pk_add_f32 v[40:41], v[40:41], v[44:45]
    v_pk_add_f32 v[48:49], v[48:49], v[52:53]
    v_pk_add_f32 v[42:43], v[42:43], v[46:47]
    v_pk_add_f32 v[50:51], v[50:51], v[54:55]
    v_pk_add_f32 v[40:41], v[40:41], v[48:49]
    v_pk_add_f32 v[42:43], v[42:43], v[50:51]
    s_nop 1
    v_permlane32_swap_b32 v40, v42
    v_permlane32_swap_b32 v41, v43
    v_pk_add_f32 v[40:41], v[40:41], v[42:43]
    s_nop 1
    v_permlane16_swap_b32 v40, v41
    v_add_f32 v4, v40, v41
    v_mov_b32 v5, 0
    v_cvt_pk_bf16_f32 v6, v4, v5
    v_and_b32 v5, 0xffff0000, v6
    v_lshlrev_b32 v4, 16, v6
    v_pk_add_f32 v[4:5], v[4:5], v[32:33]
    v_cvt_pk_bf16_f32 v24, v4, v5
    ds_write_b32 v19, v24
    s_waitcnt lgkmcnt(0)
    s_barrier
    s_branch L_fin_done
L_helper:
    s_setprio 3
    s_load_dword s56, s[28:29], 0
    s_load_dword s68, s[22:23], 0
    s_mov_b32 s44, s28
    s_and_b32 s45, s29, 0xffff
    s_mov_b32 s46, 4194304
    s_mov_b32 s47, 0x20000
    s_cmp_eq_u32 s3, 1
    s_cbranch_scc1 L_h1
    s_mov_b32 s65, 0
    v_mov_b32 v17, 0
L_lw13:
    ds_read_b32 v16, v17 offset:36
    s_waitcnt lgkmcnt(0)
    v_readfirstlane_b32 s63, v16
    s_cmp_ge_u32 s63, 1
    s_cbranch_scc1 L_lwd14
    s_add_u32 s65, s65, 1
    s_cmp_gt_u32 s65, 400000
    s_cbranch_scc1 L_end
    s_sleep 2
    s_branch L_lw13
L_lwd14:
    s_sub_u32 s64, s3, 1
    s_max_i32 s64, s64, 0
    s_mul_i32 s63, s64, 2816
    v_lshlrev_b32 v1, 4, v0
    v_add_u32 v1, s63, v1
    s_add_u32 s63, s63, 2048
    v_mul_u32_u24 v2, 12, v0
    v_add_u32 v2, s63, v2
    s_mov_b32 s48, s16
    s_and_b32 s49, s17, 0xffff
    s_mov_b32 s50, 9216
    s_mov_b32 s51, 0x20000
    buffer_load_dwordx4 v[92:95], v1, s[48:51], 0 offen
    buffer_load_dwordx4 v[96:99], v1, s[48:51], 0 offen offset:1024
    buffer_load_dwordx3 v[100:102], v2, s[48:51], 0 offen
    s_mov_b32 s48, s18
    s_nop 0
    s_and_b32 s49, s19, 0xffff
    s_mov_b32 s50, 9216
    s_mov_b32 s51, 0x20000
    buffer_load_dwordx4 v[104:107], v1, s[48:51], 0 offen
    buffer_load_dwordx4 v[108:111], v1, s[48:51], 0 offen offset:1024
    buffer_load_dwordx3 v[112:114], v2, s[48:51], 0 offen
    s_mov_b32 s48, s20
    s_nop 0
    s_and_b32 s49, s21, 0xffff
    s_mov_b32 s50, 9216
    s_mov_b32 s51, 0x20000
    buffer_load_dwordx4 v[116:119], v1, s[48:51], 0 offen
    buffer_load_dwordx4 v[120:123], v1, s[48:51], 0 offen offset:1024
    buffer_load_dwordx3 v[124:126], v2, s[48:51], 0 offen
    s_and_b32 s63, s56, 0x7f7f7f7f
    s_add_u32 s63, s63, 0x01010101
    s_and_b32 s56, s56, 0x80808080
    s_xor_b32 s56, s56, s63
    s_bfe_u32 s57, s56, 0x80000
    s_bfe_u32 s58, s56, 0x80008
    s_bfe_u32 s59, s56, 0x80010
    s_bfe_u32 s60, s56, 0x80018
    v_mov_b32 v12, 0xffffff00
    s_waitcnt vmcnt(0)
    s_branch L_table
L_h1:
    v_lshrrev_b32 v1, 5, v0
    v_lshlrev_b32 v1, 13, v1
    v_and_b32 v2, 31, v0
    v_lshl_add_u32 v1, v2, 4, v1
    s_lshl_b32 s63, s30, 14
    s_lshl_b32 s64, s31, 9
    s_add_u32 s63, s63, s64
    s_add_u32 s63, s63, 65536
    v_add_u32 v1, s63, v1
    s_movk_i32 s67, 0x1000
    v_and_b32 v2, 15, v0
    v_lshlrev_b32 v2, 4, v2
    s_lshl_b32 s63, s30, 8
    s_add_u32 s63, s63, 327680
    v_add_u32 v2, s63, v2
    s_mov_b32 s69, 0
    s_mov_b32 s65, 0
    v_mov_b32 v17, 0
L_lw15:
    ds_read_b32 v16, v17 offset:36
    s_waitcnt lgkmcnt(0)
    v_readfirstlane_b32 s63, v16
    s_cmp_ge_u32 s63, 2
    s_cbranch_scc1 L_lwd16
    s_add_u32 s65, s65, 1
    s_cmp_gt_u32 s65, 400000
    s_cbranch_scc1 L_end
    s_sleep 2
    s_branch L_lw15
L_lwd16:
    s_and_b32 s63, s56, 0x7f7f7f7f
    s_add_u32 s63, s63, 0x01010101
    s_and_b32 s56, s56, 0x80808080
    s_xor_b32 s56, s56, s63
    s_bfe_u32 s57, s56, 0x80000
    s_bfe_u32 s58, s56, 0x80008
    s_bfe_u32 s59, s56, 0x80010
    s_bfe_u32 s60, s56, 0x80018
    v_mov_b32 v12, 0xffffff00
    s_mov_b32 s65, 0
L_pl17:
    buffer_load_dwordx4 v[32:35], v1, s[44:47], 0 offen offset:0 sc1 nt
    buffer_load_dwordx4 v[36:39], v1, s[44:47], 0 offen offset:1024 sc1 nt
    buffer_load_dwordx4 v[40:43], v1, s[44:47], 0 offen offset:2048 sc1 nt
    buffer_load_dwordx4 v[44:47], v1, s[44:47], 0 offen offset:3072 sc1 nt
    buffer_load_dwordx4 v[48:51], v1, s[44:47], s67 offen offset:0 sc1 nt
    buffer_load_dwordx4 v[52:55], v1, s[44:47], s67 offen offset:1024 sc1 nt
    buffer_load_dwordx4 v[56:59], v1, s[44:47], s67 offen offset:2048 sc1 nt
    buffer_load_dwordx4 v[60:63], v1, s[44:47], s67 offen offset:3072 sc1 nt
    buffer_load_dwordx4 v[64:67], v2, s[44:47], 0 offen sc1 nt
    s_add_u32 s65, s65, 1
    s_cmp_gt_u32 s65, 20000
    s_cbranch_scc1 L_end
    s_waitcnt vmcnt(0)
    v_xor_b32 v32, s57, v32
    v_xor_b32 v33, s58, v33
    v_xor_b32 v34, s59, v34
    v_xor_b32 v35, s60, v35
    v_or3_b32 v6, v32, v33, v34
    v_or_b32 v6, v6, v35
    v_xor_b32 v36, s57, v36
    v_xor_b32 v37, s58, v37
    v_xor_b32 v38, s59, v38
    v_xor_b32 v39, s60, v39
    v_or3_b32 v6, v6, v36, v37
    v_or3_b32 v6, v6, v38, v39
    v_xor_b32 v40, s57, v40
    v_xor_b32 v41, s58, v41
    v_xor_b32 v42, s59, v42
    v_xor_b32 v43, s60, v43
    v_or3_b32 v6, v6, v40, v41
    v_or3_b32 v6, v6, v42, v43
    v_xor_b32 v44, s57, v44
    v_xor_b32 v45, s58, v45
    v_xor_b32 v46, s59, v46
    v_xor_b32 v47, s60, v47
    v_or3_b32 v6, v6, v44, v45
    v_or3_b32 v6, v6, v46, v47
    v_xor_b32 v48, s57, v48
    v_xor_b32 v49, s58, v49
    v_xor_b32 v50, s59, v50
    v_xor_b32 v51, s60, v51
    v_or3_b32 v6, v6, v48, v49
    v_or3_b32 v6, v6, v50, v51
    v_xor_b32 v52, s57, v52
    v_xor_b32 v53, s58, v53
    v_xor_b32 v54, s59, v54
    v_xor_b32 v55, s60, v55
    v_or3_b32 v6, v6, v52, v53
    v_or3_b32 v6, v6, v54, v55
    v_xor_b32 v56, s57, v56
    v_xor_b32 v57, s58, v57
    v_xor_b32 v58, s59, v58
    v_xor_b32 v59, s60, v59
    v_or3_b32 v6, v6, v56, v57
    v_or3_b32 v6, v6, v58, v59
    v_xor_b32 v60, s57, v60
    v_xor_b32 v61, s58, v61
    v_xor_b32 v62, s59, v62
    v_xor_b32 v63, s60, v63
    v_or3_b32 v6, v6, v60, v61
    v_or3_b32 v6, v6, v62, v63
    v_xor_b32 v64, s57, v64
    v_xor_b32 v65, s58, v65
    v_xor_b32 v66, s59, v66
    v_xor_b32 v67, s60, v67
    v_or3_b32 v6, v6, v64, v65
    v_or3_b32 v6, v6, v66, v67
    v_and_b32 v6, 0xff, v6
    v_cmp_ne_u32 vcc, 0, v6
    s_cbranch_vccz L_pld18
    s_mov_b64 exec, vcc
    s_cmp_lg_u32 s65, 24
    s_cbranch_scc1 L_qm19
    s_getpc_b64 s[90:91]
    s_add_u32 s90, s90, 12
    s_addc_u32 s91, s91, 0
    s_branch L_repub
L_qm19:
    s_sleep 1
    s_branch L_pl17
L_pld18:
    s_mov_b64 exec, -1
    v_pk_add_f32 v[32:33], v[32:33], v[48:49]
    v_pk_add_f32 v[34:35], v[34:35], v[50:51]
    v_pk_add_f32 v[36:37], v[36:37], v[52:53]
    v_pk_add_f32 v[38:39], v[38:39], v[54:55]
    v_pk_add_f32 v[40:41], v[40:41], v[56:57]
    v_pk_add_f32 v[42:43], v[42:43], v[58:59]
    v_pk_add_f32 v[44:45], v[44:45], v[60:61]
    v_pk_add_f32 v[46:47], v[46:47], v[62:63]
    v_pk_add_f32 v[32:33], v[32:33], v[40:41]
    v_pk_add_f32 v[34:35], v[34:35], v[42:43]
    v_pk_add_f32 v[36:37], v[36:37], v[44:45]
    v_pk_add_f32 v[38:39], v[38:39], v[46:47]
    v_pk_add_f32 v[32:33], v[32:33], v[36:37]
    v_pk_add_f32 v[34:35], v[34:35], v[38:39]
    v_cvt_pk_bf16_f32 v32, v32, v33
    v_cvt_pk_bf16_f32 v33, v34, v35
    v_lshlrev_b32 v1, 3, v0
    ds_write_b64 v1, v[32:33] offset:64
    s_getreg_b32 s63, hwreg(HW_REG_XCC_ID)
    s_and_b32 s63, s63, 0xff
    v_lshrrev_b32 v64, 8, v64
    v_cmp_ne_u32 vcc, s63, v64
    s_cmp_eq_u64 vcc, 0
    s_cselect_b32 s88, 1, 0
    v_mov_b32 v1, 0
    v_mov_b32 v2, s88
    v_mov_b32 v3, s56
    ds_write_b64 v1, v[2:3] offset:24
    v_mov_b32 v2, 1
    ds_write_b32 v1, v2 offset:0
    s_or_b32 s63, s88, s69
    s_cbranch_scc1 L_h1w
    s_getpc_b64 s[90:91]
    s_add_u32 s90, s90, 12
    s_addc_u32 s91, s91, 0
    s_branch L_repub
L_h1w:
    s_movk_i32 s63, 8448
    v_mul_u32_u24 v2, 12, v0
    v_add_u32 v2, s63, v2
    s_mov_b32 s48, s16
    s_and_b32 s49, s17, 0xffff
    s_mov_b32 s50, 9216
    s_mov_b32 s51, 0x20000
    buffer_load_dwordx3 v[92:94], v2, s[48:51], 0 offen
    s_mov_b32 s48, s18
    s_and_b32 s49, s19, 0xffff
    s_mov_b32 s50, 9216
    s_mov_b32 s51, 0x20000
    buffer_load_dwordx3 v[104:106], v2, s[48:51], 0 offen
    s_mov_b32 s48, s20
    s_and_b32 s49, s21, 0xffff
    s_mov_b32 s50, 9216
    s_mov_b32 s51, 0x20000
    buffer_load_dwordx3 v[116:118], v2, s[48:51], 0 offen
    s_waitcnt vmcnt(0)
    s_setprio 0
    v_and_b32 v33, 0xffff0000, v92
    v_lshlrev_b32 v32, 16, v92
    v_and_b32 v35, 0xffff0000, v93
    v_lshlrev_b32 v34, 16, v93
    v_and_b32 v37, 0xffff0000, v94
    v_lshlrev_b32 v36, 16, v94
    v_and_b32 v55, 0xffff0000, v104
    v_lshlrev_b32 v54, 16, v104
    v_and_b32 v57, 0xffff0000, v105
    v_lshlrev_b32 v56, 16, v105
    v_and_b32 v59, 0xffff0000, v106
    v_lshlrev_b32 v58, 16, v106
    v_and_b32 v77, 0xffff0000, v116
    v_lshlrev_b32 v76, 16, v116
    v_and_b32 v79, 0xffff0000, v117
    v_lshlrev_b32 v78, 16, v117
    v_and_b32 v81, 0xffff0000, v118
    v_lshlrev_b32 v80, 16, v118
    v_mov_b32 v14, 0xc0135761
    s_mov_b32 s66, 0xbdd2d3e8
    s_mul_i32 s63, s2, 20
    s_add_u32 s64, s63, 20
    v_lshrrev_b32 v1, 4, v0
    s_lshl_b32 s67, s3, 2
    v_add_u32 v1, s67, v1
    v_lshlrev_b32 v1, 2, v1
L_tloops:
    s_lshr_b32 s90, s63, 1
    s_add_u32 s90, s90, 14080
    s_lshl_b32 s90, s90, 16
    s_lshl_b32 s91, s63, 31
    s_or_b32 s90, s90, s91
    s_nop 0
    v_pk_fma_f32 v[100:101], v[32:33], s[90:91], v[54:55] op_sel_hi:[1,0,1]
    v_pk_fma_f32 v[102:103], v[34:35], s[90:91], v[56:57] op_sel_hi:[1,0,1]
    v_pk_fma_f32 v[104:105], v[36:37], s[90:91], v[58:59] op_sel_hi:[1,0,1]
    v_pk_mul_f32 v[112:113], v[100:101], v[100:101]
    v_pk_mul_f32 v[114:115], v[102:103], v[102:103]
    v_pk_mul_f32 v[116:117], v[104:105], v[104:105]
    v_pk_fma_f32 v[112:113], v[112:113], s[66:67], v[14:15] op_sel_hi:[1,0,0]
    v_pk_fma_f32 v[114:115], v[114:115], s[66:67], v[14:15] op_sel_hi:[1,0,0]
    v_pk_fma_f32 v[116:117], v[116:117], s[66:67], v[14:15] op_sel_hi:[1,0,0]
    v_pk_mul_f32 v[112:113], v[112:113], v[100:101]
    v_pk_mul_f32 v[114:115], v[114:115], v[102:103]
    v_pk_mul_f32 v[116:117], v[116:117], v[104:105]
    v_exp_f32 v112, v112
    v_exp_f32 v113, v113
    v_exp_f32 v114, v114
    v_exp_f32 v115, v115
    v_exp_f32 v116, v116
    v_exp_f32 v117, v117
    v_pk_add_f32 v[112:113], v[112:113], 1.0 op_sel_hi:[1,0]
    v_pk_add_f32 v[114:115], v[114:115], 1.0 op_sel_hi:[1,0]
    v_pk_add_f32 v[116:117], v[116:117], 1.0 op_sel_hi:[1,0]
    v_rcp_f32 v112, v112
    v_rcp_f32 v113, v113
    v_rcp_f32 v114, v114
    v_rcp_f32 v115, v115
    v_rcp_f32 v116, v116
    v_rcp_f32 v117, v117
    v_pk_mul_f32 v[100:101], v[100:101], v[112:113]
    v_pk_mul_f32 v[102:103], v[102:103], v[114:115]
    v_pk_mul_f32 v[104:105], v[104:105], v[116:117]
    v_pk_mul_f32 v[16:17], v[100:101], v[76:77]
    v_pk_fma_f32 v[16:17], v[102:103], v[78:79], v[16:17]
    v_pk_fma_f32 v[16:17], v[104:105], v[80:81], v[16:17]
    v_add_f32 v16, v16, v17
    s_nop 1
    v_add_f32_dpp v16, v16, v16 quad_perm:[1,0,3,2] row_mask:0xf bank_mask:0xf
    s_nop 1
    v_add_f32_dpp v16, v16, v16 quad_perm:[2,3,0,1] row_mask:0xf bank_mask:0xf
    s_nop 1
    v_add_f32_dpp v16, v16, v16 row_half_mirror row_mask:0xf bank_mask:0xf
    s_nop 1
    v_add_f32_dpp v16, v16, v16 row_mirror row_mask:0xf bank_mask:0xf
    ds_write_b32 v1, v16 offset:3072
    v_add_u32 v1, 64, v1
    s_add_u32 s63, s63, 1
    s_cmp_lt_u32 s63, s64
    s_cbranch_scc1 L_tloops
    s_branch L_tfin
L_table:
    s_setprio 0
    v_and_b32 v33, 0xffff0000, v92
    v_lshlrev_b32 v32, 16, v92
    v_and_b32 v35, 0xffff0000, v93
    v_lshlrev_b32 v34, 16, v93
    v_and_b32 v37, 0xffff0000, v94
    v_lshlrev_b32 v36, 16, v94
    v_and_b32 v39, 0xffff0000, v95
    v_lshlrev_b32 v38, 16, v95
    v_and_b32 v41, 0xffff0000, v96
    v_lshlrev_b32 v40, 16, v96
    v_and_b32 v43, 0xffff0000, v97
    v_lshlrev_b32 v42, 16, v97
    v_and_b32 v45, 0xffff0000, v98
    v_lshlrev_b32 v44, 16, v98
    v_and_b32 v47, 0xffff0000, v99
    v_lshlrev_b32 v46, 16, v99
    v_and_b32 v49, 0xffff0000, v100
    v_lshlrev_b32 v48, 16, v100
    v_and_b32 v51, 0xffff0000, v101
    v_lshlrev_b32 v50, 16, v101
    v_and_b32 v53, 0xffff0000, v102
    v_lshlrev_b32 v52, 16, v102
    v_and_b32 v55, 0xffff0000, v104
    v_lshlrev_b32 v54, 16, v104
    v_and_b32 v57, 0xffff0000, v105
    v_lshlrev_b32 v56, 16, v105
    v_and_b32 v59, 0xffff0000, v106
    v_lshlrev_b32 v58, 16, v106
    v_and_b32 v61, 0xffff0000, v107
    v_lshlrev_b32 v60, 16, v107
    v_and_b32 v63, 0xffff0000, v108
    v_lshlrev_b32 v62, 16, v108
    v_and_b32 v65, 0xffff0000, v109
    v_lshlrev_b32 v64, 16, v109
    v_and_b32 v67, 0xffff0000, v110
    v_lshlrev_b32 v66, 16, v110
    v_and_b32 v69, 0xffff0000, v111
    v_lshlrev_b32 v68, 16, v111
    v_and_b32 v71, 0xffff0000, v112
    v_lshlrev_b32 v70, 16, v112
    v_and_b32 v73, 0xffff0000, v113
    v_lshlrev_b32 v72, 16, v113
    v_and_b32 v75, 0xffff0000, v114
    v_lshlrev_b32 v74, 16, v114
    v_and_b32 v77, 0xffff0000, v116
    v_lshlrev_b32 v76, 16, v116
    v_and_b32 v79, 0xffff0000, v117
    v_lshlrev_b32 v78, 16, v117
    v_and_b32 v81, 0xffff0000, v118
    v_lshlrev_b32 v80, 16, v118
    v_and_b32 v83, 0xffff0000, v119
    v_lshlrev_b32 v82, 16, v119
    v_and_b32 v85, 0xffff0000, v120
    v_lshlrev_b32 v84, 16, v120
    v_and_b32 v87, 0xffff0000, v121
    v_lshlrev_b32 v86, 16, v121
    v_and_b32 v89, 0xffff0000, v122
    v_lshlrev_b32 v88, 16, v122
    v_and_b32 v91, 0xffff0000, v123
    v_lshlrev_b32 v90, 16, v123
    v_and_b32 v93, 0xffff0000, v124
    v_lshlrev_b32 v92, 16, v124
    v_and_b32 v95, 0xffff0000, v125
    v_lshlrev_b32 v94, 16, v125
    v_and_b32 v97, 0xffff0000, v126
    v_lshlrev_b32 v96, 16, v126
    v_mov_b32 v14, 0xc0135761
    s_mov_b32 s66, 0xbdd2d3e8
    s_mul_i32 s63, s2, 20
    s_add_u32 s64, s63, 20
    v_lshrrev_b32 v1, 4, v0
    s_lshl_b32 s67, s3, 2
    v_add_u32 v1, s67, v1
    v_lshlrev_b32 v1, 2, v1
L_tloopb:
    s_lshr_b32 s90, s63, 1
    s_add_u32 s90, s90, 14080
    s_lshl_b32 s90, s90, 16
    s_lshl_b32 s91, s63, 31
    s_or_b32 s90, s90, s91
    v_pk_fma_f32 v[100:101], v[32:33], s[90:91], v[54:55] op_sel_hi:[1,0,1]
    v_pk_fma_f32 v[102:103], v[34:35], s[90:91], v[56:57] op_sel_hi:[1,0,1]
    v_pk_fma_f32 v[104:105], v[36:37], s[90:91], v[58:59] op_sel_hi:[1,0,1]
    v_pk_fma_f32 v[106:107], v[38:39], s[90:91], v[60:61] op_sel_hi:[1,0,1]
    v_pk_fma_f32 v[108:109], v[40:41], s[90:91], v[62:63] op_sel_hi:[1,0,1]
    v_pk_fma_f32 v[110:111], v[42:43], s[90:91], v[64:65] op_sel_hi:[1,0,1]
    v_pk_mul_f32 v[112:113], v[100:101], v[100:101]
    v_pk_mul_f32 v[114:115], v[102:103], v[102:103]
    v_pk_mul_f32 v[116:117], v[104:105], v[104:105]
    v_pk_mul_f32 v[118:119], v[106:107], v[106:107]
    v_pk_mul_f32 v[120:121], v[108:109], v[108:109]
    v_pk_mul_f32 v[122:123], v[110:111], v[110:111]
    v_pk_fma_f32 v[112:113], v[112:113], s[66:67], v[14:15] op_sel_hi:[1,0,0]
    v_pk_fma_f32 v[114:115], v[114:115], s[66:67], v[14:15] op_sel_hi:[1,0,0]
    v_pk_fma_f32 v[116:117], v[116:117], s[66:67], v[14:15] op_sel_hi:[1,0,0]
    v_pk_fma_f32 v[118:119], v[118:119], s[66:67], v[14:15] op_sel_hi:[1,0,0]
    v_pk_fma_f32 v[120:121], v[120:121], s[66:67], v[14:15] op_sel_hi:[1,0,0]
    v_pk_fma_f32 v[122:123], v[122:123], s[66:67], v[14:15] op_sel_hi:[1,0,0]
    v_pk_mul_f32 v[112:113], v[112:113], v[100:101]
    v_pk_mul_f32 v[114:115], v[114:115], v[102:103]
    v_pk_mul_f32 v[116:117], v[116:117], v[104:105]
    v_pk_mul_f32 v[118:119], v[118:119], v[106:107]
    v_pk_mul_f32 v[120:121], v[120:121], v[108:109]
    v_pk_mul_f32 v[122:123], v[122:123], v[110:111]
    v_exp_f32 v112, v112
    v_exp_f32 v113, v113
    v_exp_f32 v114, v114
    v_exp_f32 v115, v115
    v_exp_f32 v116, v116
    v_exp_f32 v117, v117
    v_exp_f32 v118, v118
    v_exp_f32 v119, v119
    v_exp_f32 v120, v120
    v_exp_f32 v121, v121
    v_exp_f32 v122, v122
    v_exp_f32 v123, v123
    v_pk_add_f32 v[112:113], v[112:113], 1.0 op_sel_hi:[1,0]
    v_pk_add_f32 v[114:115], v[114:115], 1.0 op_sel_hi:[1,0]
    v_pk_add_f32 v[116:117], v[116:117], 1.0 op_sel_hi:[1,0]
    v_pk_add_f32 v[118:119], v[118:119], 1.0 op_sel_hi:[1,0]
    v_pk_add_f32 v[120:121], v[120:121], 1.0 op_sel_hi:[1,0]
    v_pk_add_f32 v[122:123], v[122:123], 1.0 op_sel_hi:[1,0]
    v_rcp_f32 v112, v112
    v_rcp_f32 v113, v113
    v_rcp_f32 v114, v114
    v_rcp_f32 v115, v115
    v_rcp_f32 v116, v116
    v_rcp_f32 v117, v117
    v_rcp_f32 v118, v118
    v_rcp_f32 v119, v119
    v_rcp_f32 v120, v120
    v_rcp_f32 v121, v121
    v_rcp_f32 v122, v122
    v_rcp_f32 v123, v123
    v_pk_mul_f32 v[100:101], v[100:101], v[112:113]
    v_pk_mul_f32 v[102:103], v[102:103], v[114:115]
    v_pk_mul_f32 v[104:105], v[104:105], v[116:117]
    v_pk_mul_f32 v[106:107], v[106:107], v[118:119]
    v_pk_mul_f32 v[108:109], v[108:109], v[120:121]
    v_pk_mul_f32 v[110:111], v[110:111], v[122:123]
    v_pk_mul_f32 v[16:17], v[100:101], v[76:77]
    v_pk_fma_f32 v[16:17], v[102:103], v[78:79], v[16:17]
    v_pk_fma_f32 v[16:17], v[104:105], v[80:81], v[16:17]
    v_pk_fma_f32 v[16:17], v[106:107], v[82:83], v[16:17]
    v_pk_fma_f32 v[16:17], v[108:109], v[84:85], v[16:17]
    v_pk_fma_f32 v[16:17], v[110:111], v[86:87], v[16:17]
    v_pk_fma_f32 v[100:101], v[44:45], s[90:91], v[66:67] op_sel_hi:[1,0,1]
    v_pk_fma_f32 v[102:103], v[46:47], s[90:91], v[68:69] op_sel_hi:[1,0,1]
    v_pk_fma_f32 v[104:105], v[48:49], s[90:91], v[70:71] op_sel_hi:[1,0,1]
    v_pk_fma_f32 v[106:107], v[50:51], s[90:91], v[72:73] op_sel_hi:[1,0,1]
    v_pk_fma_f32 v[108:109], v[52:53], s[90:91], v[74:75] op_sel_hi:[1,0,1]
    v_pk_mul_f32 v[112:113], v[100:101], v[100:101]
    v_pk_mul_f32 v[114:115], v[102:103], v[102:103]
    v_pk_mul_f32 v[116:117], v[104:105], v[104:105]
    v_pk_mul_f32 v[118:119], v[106:107], v[106:107]
    v_pk_mul_f32 v[120:121], v[108:109], v[108:109]
    v_pk_fma_f32 v[112:113], v[112:113], s[66:67], v[14:15] op_sel_hi:[1,0,0]
    v_pk_fma_f32 v[114:115], v[114:115], s[66:67], v[14:15] op_sel_hi:[1,0,0]
    v_pk_fma_f32 v[116:117], v[116:117], s[66:67], v[14:15] op_sel_hi:[1,0,0]
    v_pk_fma_f32 v[118:119], v[118:119], s[66:67], v[14:15] op_sel_hi:[1,0,0]
    v_pk_fma_f32 v[120:121], v[120:121], s[66:67], v[14:15] op_sel_hi:[1,0,0]
    v_pk_mul_f32 v[112:113], v[112:113], v[100:101]
    v_pk_mul_f32 v[114:115], v[114:115], v[102:103]
    v_pk_mul_f32 v[116:117], v[116:117], v[104:105]
    v_pk_mul_f32 v[118:119], v[118:119], v[106:107]
    v_pk_mul_f32 v[120:121], v[120:121], v[108:109]
    v_exp_f32 v112, v112
    v_exp_f32 v113, v113
    v_exp_f32 v114, v114
    v_exp_f32 v115, v115
    v_exp_f32 v116, v116
    v_exp_f32 v117, v117
    v_exp_f32 v118, v118
    v_exp_f32 v119, v119
    v_exp_f32 v120, v120
    v_exp_f32 v121, v121
    v_pk_add_f32 v[112:113], v[112:113], 1.0 op_sel_hi:[1,0]
    v_pk_add_f32 v[114:115], v[114:115], 1.0 op_sel_hi:[1,0]
    v_pk_add_f32 v[116:117], v[116:117], 1.0 op_sel_hi:[1,0]
    v_pk_add_f32 v[118:119], v[118:119], 1.0 op_sel_hi:[1,0]
    v_pk_add_f32 v[120:121], v[120:121], 1.0 op_sel_hi:[1,0]
    v_rcp_f32 v112, v112
    v_rcp_f32 v113, v113
    v_rcp_f32 v114, v114
    v_rcp_f32 v115, v115
    v_rcp_f32 v116, v116
    v_rcp_f32 v117, v117
    v_rcp_f32 v118, v118
    v_rcp_f32 v119, v119
    v_rcp_f32 v120, v120
    v_rcp_f32 v121, v121
    v_pk_mul_f32 v[100:101], v[100:101], v[112:113]
    v_pk_mul_f32 v[102:103], v[102:103], v[114:115]
    v_pk_mul_f32 v[104:105], v[104:105], v[116:117]
    v_pk_mul_f32 v[106:107], v[106:107], v[118:119]
    v_pk_mul_f32 v[108:109], v[108:109], v[120:121]
    v_pk_fma_f32 v[16:17], v[100:101], v[88:89], v[16:17]
    v_pk_fma_f32 v[16:17], v[102:103], v[90:91], v[16:17]
    v_pk_fma_f32 v[16:17], v[104:105], v[92:93], v[16:17]
    v_pk_fma_f32 v[16:17], v[106:107], v[94:95], v[16:17]
    v_pk_fma_f32 v[16:17], v[108:109], v[96:97], v[16:17]
    v_add_f32 v16, v16, v17
    s_nop 1
    v_add_f32_dpp v16, v16, v16 quad_perm:[1,0,3,2] row_mask:0xf bank_mask:0xf
    s_nop 1
    v_add_f32_dpp v16, v16, v16 quad_perm:[2,3,0,1] row_mask:0xf bank_mask:0xf
    s_nop 1
    v_add_f32_dpp v16, v16, v16 row_half_mirror row_mask:0xf bank_mask:0xf
    s_nop 1
    v_add_f32_dpp v16, v16, v16 row_mirror row_mask:0xf bank_mask:0xf
    ds_write_b32 v1, v16 offset:3072
    v_add_u32 v1, 64, v1
    s_add_u32 s63, s63, 1
    s_cmp_lt_u32 s63, s64
    s_cbranch_scc1 L_tloopb
L_tfin:
    v_mov_b32 v1, 0
    v_mov_b32 v2, 1
    s_mov_b64 exec, 1
    ds_add_rtn_u32 v2, v1, v2 offset:4
    s_mov_b64 exec, -1
    s_waitcnt lgkmcnt(0)
    v_readfirstlane_b32 s63, v2
    s_cmp_lg_u32 s63, 3
    s_cbranch_scc1 L_wo
    v_lshlrev_b32 v1, 6, v0
    s_mov_b64 exec, 1048575
    ds_read_b128 v[88:91], v1 offset:3072
    ds_read_b128 v[92:95], v1 offset:3088
    ds_read_b128 v[96:99], v1 offset:3104
    ds_read_b128 v[100:103], v1 offset:3120
    s_waitcnt lgkmcnt(0)
    s_nop 0
    v_pk_add_f32 v[88:89], v[88:89], v[96:97]
    v_pk_add_f32 v[90:91], v[90:91], v[98:99]
    v_pk_add_f32 v[92:93], v[92:93], v[100:101]
    v_pk_add_f32 v[94:95], v[94:95], v[102:103]
    v_pk_add_f32 v[88:89], v[88:89], v[92:93]
    v_pk_add_f32 v[90:91], v[90:91], v[94:95]
    v_pk_add_f32 v[88:89], v[88:89], v[90:91]
    v_add_f32 v4, v88, v89
    v_cvt_pk_bf16_f32 v4, v4, v4
    v_and_b32 v4, 0xffff0000, v4
    s_lshl_b32 s68, s68, 16
    v_add_f32 v4, s68, v4
    v_cvt_pk_bf16_f32 v4, v4, v4
    v_and_b32 v4, 0xffff0000, v4
    v_and_b32 v2, 3, v0
    v_lshlrev_b32 v2, 3, v2
    v_lshrrev_b32 v2, v2, s56
    v_and_b32 v2, 0xff, v2
    v_or_b32 v4, v4, v2
    s_mul_i32 s63, s2, 80
    s_add_u32 s63, s63, 851968
    v_lshl_add_u32 v1, v0, 2, s63
    buffer_store_dword v4, v1, s[44:47], 0 offen sc1
    s_mov_b64 exec, -1
L_wo:
    v_and_b32 v2, 1, v0
    v_lshlrev_b32 v2, 4, v2
    v_mov_b32 v3, 0xffff
    v_lshlrev_b32 v2, v2, v3
    v_bfe_u32 v3, v0, 1, 2
    v_cmp_eq_u32 vcc, 0, v3
    s_nop 1
    v_cndmask_b32 v8, 0, v2, vcc
    v_cmp_eq_u32 vcc, 1, v3
    s_nop 1
    v_cndmask_b32 v9, 0, v2, vcc
    v_cmp_eq_u32 vcc, 2, v3
    s_nop 1
    v_cndmask_b32 v10, 0, v2, vcc
    v_cmp_eq_u32 vcc, 3, v3
    s_nop 1
    v_cndmask_b32 v11, 0, v2, vcc
    s_lshl_b32 s63, s30, 8
    s_lshl_b32 s64, s3, 6
    s_add_u32 s63, s63, s64
    s_mul_i32 s63, s63, 1152
    s_add_u32 s48, s12, s63
    s_addc_u32 s49, s13, 0
    s_and_b32 s49, s49, 0xffff
    s_mov_b32 s50, 73728
    s_mov_b32 s51, 0x20000
    v_lshrrev_b32 v1, 3, v0
    v_mul_u32_u24 v1, 1152, v1
    v_and_b32 v2, 7, v0
    v_lshl_add_u32 v1, v2, 4, v1
    s_lshl_b32 s63, s32, 7
    v_add_u32 v13, s63, v1
    v_lshrrev_b32 v1, 3, v0
    v_lshlrev_b32 v1, 4, v1
    v_lshl_add_u32 v1, v2, 10, v1
    s_lshl_b32 s63, s33, 13
    s_lshl_b32 s64, s3, 8
    s_add_u32 s63, s63, s64
    s_add_u32 s63, s63, 524288
    v_add_u32 v1, s63, v1
    v_lshrrev_b32 v3, 5, v0
    v_lshlrev_b32 v3, 8, v3
    v_lshl_add_u32 v3, v2, 5, v3
    v_bfe_u32 v14, v0, 4, 1
    v_lshl_add_u32 v3, v14, 4, v3
    s_lshl_b32 s63, s3, 9
    v_add_u32 v3, s63, v3
    v_lshlrev_b32 v15, 2, v0
    s_lshl_b32 s63, s3, 11
    v_add_u32 v14, s63, v15
    s_mul_i32 s63, s31, 9
    s_cmp_eq_u32 s3, 0
    s_cselect_b32 s64, s32, 8
    s_add_u32 s63, s63, s64
    s_lshl_b32 s63, s63, 4
    s_add_u32 s63, s63, s30
    s_lshl_b32 s63, s63, 8
    s_add_u32 s63, s63, 917504
    v_add_u32 v15, s63, v15
    v_and_b32 v20, 3, v0
    v_lshlrev_b32 v20, 3, v20
    v_lshrrev_b32 v20, v20, s56
    v_and_b32 v20, 0xff, v20
    s_mov_b32 s66, 0x00ff00ff
    s_mov_b32 s67, 0xff00ff00
    s_cmp_lg_u32 s3, 1
    s_cbranch_scc1 L_wo_b2
    v_bfe_u32 v21, v0, 3, 1
    v_lshlrev_b32 v21, 4, v21
    s_lshl_b32 s63, s34, 5
    s_add_u32 s63, s63, 786432
    v_add_u32 v22, s63, v21
    v_lshl_add_u32 v21, v2, 5, v21
    s_lshl_b32 s63, s33, 8
    s_add_u32 s63, s63, 786432
    v_add_u32 v21, s63, v21
    s_mov_b32 s65, 0
    v_mov_b32 v17, 0
L_lw20:
    ds_read_b32 v16, v17 offset:16
    s_waitcnt lgkmcnt(0)
    v_readfirstlane_b32 s63, v16
    s_cmp_ge_u32 s63, 4
    s_cbranch_scc1 L_lwd21
    s_add_u32 s65, s65, 1
    s_cmp_gt_u32 s65, 400000
    s_cbranch_scc1 L_end
    s_sleep 1
    s_branch L_lw20
L_lwd21:
    s_setprio 3
    v_lshlrev_b32 v16, 3, v0
    ds_read_b64 v[40:41], v16 offset:9216
    ds_read_b64 v[42:43], v16 offset:9728
    ds_read_b64 v[44:45], v16 offset:10240
    ds_read_b64 v[46:47], v16 offset:10752
    s_waitcnt lgkmcnt(0)
    s_lshl_b32 s63, s33, 3
    s_mov_b32 s90, 1
    s_atomic_add s90, s[26:27], s63 glc
    v_max3_f32 v48, v40, v42, v44
    v_max_f32 v48, v48, v46
    v_and_b32 v48, v12, v48
    v_sub_f32 v52, v40, v48
    v_sub_f32 v53, v42, v48
    v_sub_f32 v54, v44, v48
    v_sub_f32 v55, v46, v48
    v_mul_f32 v52, 0x3fb8aa3b, v52
    v_mul_f32 v53, 0x3fb8aa3b, v53
    v_mul_f32 v54, 0x3fb8aa3b, v54
    v_mul_f32 v55, 0x3fb8aa3b, v55
    v_exp_f32 v52, v52
    v_exp_f32 v53, v53
    v_exp_f32 v54, v54
    v_exp_f32 v55, v55
    v_mul_f32 v49, v52, v41
    v_fmac_f32 v49, v53, v43
    v_fmac_f32 v49, v54, v45
    v_fmac_f32 v49, v55, v47
    v_mov_b32 v50, 0
    v_mov_b32 v51, 0
    v_mov_b32 v23, v48
    v_and_or_b32 v48, v48, v12, s57
    v_and_or_b32 v49, v49, v12, s58
    v_and_or_b32 v50, v50, v12, s59
    v_and_or_b32 v51, v51, v12, s60
    s_mov_b64 exec, 0x0101
    s_cmp_eq_u32 s88, 0
    s_cbranch_scc1 L_sl22
    buffer_store_dwordx4 v[48:51], v22, s[44:47], 0 offen
    s_branch L_sd23
L_sl22:
    buffer_store_dwordx4 v[48:51], v22, s[44:47], 0 offen sc1
L_sd23:
    s_mov_b64 exec, -1
    s_mov_b32 s65, 0
L_pl24:
    buffer_load_dwordx4 v[56:59], v21, s[44:47], 0 offen sc1 nt
    s_add_u32 s65, s65, 1
    s_cmp_gt_u32 s65, 20000
    s_cbranch_scc1 L_end
    s_waitcnt vmcnt(0)
    v_xor_b32 v56, s57, v56
    v_xor_b32 v57, s58, v57
    v_xor_b32 v58, s59, v58
    v_xor_b32 v59, s60, v59
    v_or3_b32 v6, v56, v57, v58
    v_or_b32 v6, v6, v59
    v_and_b32 v6, 0xff, v6
    v_cmp_ne_u32 vcc, 0, v6
    s_cbranch_vccz L_pld25
    s_mov_b64 exec, vcc
    s_branch L_pl24
L_pld25:
    s_mov_b64 exec, -1
    v_mov_b32 v58, v56
    s_nop 1
    v_max_f32_dpp v58, v58, v58 quad_perm:[1,0,3,2] row_mask:0xf bank_mask:0xf
    s_nop 1
    v_max_f32_dpp v58, v58, v58 quad_perm:[2,3,0,1] row_mask:0xf bank_mask:0xf
    s_nop 1
    v_max_f32_dpp v58, v58, v58 row_half_mirror row_mask:0xf bank_mask:0xf
    v_sub_f32 v56, v56, v58
    v_sub_f32 v23, v23, v58
    v_mul_f32 v56, 0x3fb8aa3b, v56
    v_mul_f32 v23, 0x3fb8aa3b, v23
    v_exp_f32 v56, v56
    v_exp_f32 v23, v23
    v_mul_f32 v57, v57, v56
    s_nop 1
    v_add_f32_dpp v57, v57, v57 quad_perm:[1,0,3,2] row_mask:0xf bank_mask:0xf
    s_nop 1
    v_add_f32_dpp v57, v57, v57 quad_perm:[2,3,0,1] row_mask:0xf bank_mask:0xf
    s_nop 1
    v_add_f32_dpp v57, v57, v57 row_half_mirror row_mask:0xf bank_mask:0xf
    v_rcp_f32 v57, v57
    s_nop 0
    v_mul_f32 v23, v23, v57
    v_mul_f32 v52, v52, v23
    v_mul_f32 v53, v53, v23
    v_mul_f32 v54, v54, v23
    v_mul_f32 v55, v55, v23
    v_lshlrev_b32 v16, 4, v0
    ds_write_b128 v16, v[52:55] offset:15360
    v_mov_b32 v16, 0
    v_mov_b32 v17, 1
    s_mov_b64 exec, 1
    ds_add_u32 v16, v17 offset:20
    s_mov_b64 exec, -1
    s_waitcnt lgkmcnt(0)
    s_and_b32 s90, s90, 7
    s_cselect_b32 s69, 1, 2
    v_mov_b32 v17, s69
    ds_write_b32 v16, v17 offset:12
    s_setprio 0
L_wo_b2:
    s_mov_b32 s69, 0
    s_mov_b32 s65, 0
    v_mov_b32 v18, 0
L_wo_w:
    ds_read_b64 v[16:17], v18 offset:8
    s_waitcnt lgkmcnt(0)
    v_readfirstlane_b32 s89, v16
    v_readfirstlane_b32 s63, v17
    s_lshr_b32 s63, s63, 1
    s_cmp_gt_u32 s63, s69
    s_cbranch_scc0 L_wo_w1
    s_mov_b32 s69, 1
    s_movk_i32 s63, 9216
    s_lshl_b32 s64, s32, 7
    s_sub_u32 s64, 1024, s64
    buffer_load_dwordx4 a[32:35], v13, s[48:51], s64 offen nt
    s_add_u32 s64, s64, s63
    buffer_load_dwordx4 a[36:39], v13, s[48:51], s64 offen nt
    s_add_u32 s64, s64, s63
    buffer_load_dwordx4 a[40:43], v13, s[48:51], s64 offen nt
    s_add_u32 s64, s64, s63
    buffer_load_dwordx4 a[44:47], v13, s[48:51], s64 offen nt
    s_add_u32 s64, s64, s63
    buffer_load_dwordx4 a[48:51], v13, s[48:51], s64 offen nt
    s_add_u32 s64, s64, s63
    buffer_load_dwordx4 a[52:55], v13, s[48:51], s64 offen nt
    s_add_u32 s64, s64, s63
    buffer_load_dwordx4 a[56:59], v13, s[48:51], s64 offen nt
    s_add_u32 s64, s64, s63
    buffer_load_dwordx4 a[60:63], v13, s[48:51], s64 offen nt
    s_add_u32 s64, s64, s63
L_wo_w1:
    s_cmp_ge_u32 s89, 32
    s_cbranch_scc1 L_wo_wf
    s_add_u32 s65, s65, 1
    s_cmp_gt_u32 s65, 400000
    s_cbranch_scc1 L_end
    s_sleep 2
    s_branch L_wo_w
L_wo_wf:
    s_setprio 3
    s_movk_i32 s63, 9216
    s_mov_b32 s64, 0
    buffer_load_dwordx4 a[0:3], v13, s[48:51], s64 offen nt
    s_add_u32 s64, s64, s63
    buffer_load_dwordx4 a[4:7], v13, s[48:51], s64 offen nt
    s_add_u32 s64, s64, s63
    buffer_load_dwordx4 a[8:11], v13, s[48:51], s64 offen nt
    s_add_u32 s64, s64, s63
    buffer_load_dwordx4 a[12:15], v13, s[48:51], s64 offen nt
    s_add_u32 s64, s64, s63
    buffer_load_dwordx4 a[16:19], v13, s[48:51], s64 offen nt
    s_add_u32 s64, s64, s63
    buffer_load_dwordx4 a[20:23], v13, s[48:51], s64 offen nt
    s_add_u32 s64, s64, s63
    buffer_load_dwordx4 a[24:27], v13, s[48:51], s64 offen nt
    s_add_u32 s64, s64, s63
    buffer_load_dwordx4 a[28:31], v13, s[48:51], s64 offen nt
    s_add_u32 s64, s64, s63
    s_cmp_eq_u32 s2, 8
    s_cbranch_scc1 L_tgather
    s_cmp_lg_u32 s2, 76
    s_cbranch_scc1 L_tg_end
L_tgather:
    s_mul_i32 s63, s3, 5120
    v_lshlrev_b32 v16, 4, v0
    v_add_u32 v16, s63, v16
    v_add_u32 v17, 851968, v16
    s_movk_i32 s64, 0x1000
    s_mov_b32 s65, 0
L_pl26:
    buffer_load_dwordx4 v[32:35], v17, s[44:47], 0 offen offset:0 sc1
    buffer_load_dwordx4 v[36:39], v17, s[44:47], 0 offen offset:1024 sc1
    buffer_load_dwordx4 v[40:43], v17, s[44:47], 0 offen offset:2048 sc1
    buffer_load_dwordx4 v[44:47], v17, s[44:47], 0 offen offset:3072 sc1
    buffer_load_dwordx4 v[48:51], v17, s[44:47], s64 offen offset:0 sc1
    s_add_u32 s65, s65, 1
    s_cmp_gt_u32 s65, 20000
    s_cbranch_scc1 L_end
    s_waitcnt vmcnt(0)
    v_xor_b32 v32, s57, v32
    v_xor_b32 v33, s58, v33
    v_xor_b32 v34, s59, v34
    v_xor_b32 v35, s60, v35
    v_or3_b32 v6, v32, v33, v34
    v_or_b32 v6, v6, v35
    v_xor_b32 v36, s57, v36
    v_xor_b32 v37, s58, v37
    v_xor_b32 v38, s59, v38
    v_xor_b32 v39, s60, v39
    v_or3_b32 v6, v6, v36, v37
    v_or3_b32 v6, v6, v38, v39
    v_xor_b32 v40, s57, v40
    v_xor_b32 v41, s58, v41
    v_xor_b32 v42, s59, v42
    v_xor_b32 v43, s60, v43
    v_or3_b32 v6, v6, v40, v41
    v_or3_b32 v6, v6, v42, v43
    v_xor_b32 v44, s57, v44
    v_xor_b32 v45, s58, v45
    v_xor_b32 v46, s59, v46
    v_xor_b32 v47, s60, v47
    v_or3_b32 v6, v6, v44, v45
    v_or3_b32 v6, v6, v46, v47
    v_xor_b32 v48, s57, v48
    v_xor_b32 v49, s58, v49
    v_xor_b32 v50, s59, v50
    v_xor_b32 v51, s60, v51
    v_or3_b32 v6, v6, v48, v49
    v_or3_b32 v6, v6, v50, v51
    v_and_b32 v6, 0xff, v6
    v_cmp_ne_u32 vcc, 0, v6
    s_cbranch_vccz L_pld27
    s_mov_b64 exec, vcc
    s_sleep 2
    s_branch L_pl26
L_pld27:
    s_mov_b64 exec, -1
    ds_write_b128 v16, v[32:35] offset:20480
    ds_write_b128 v16, v[36:39] offset:21504
    ds_write_b128 v16, v[40:43] offset:22528
    ds_write_b128 v16, v[44:47] offset:23552
    ds_write_b128 v16, v[48:51] offset:24576
L_tg_end:
    s_mov_b32 s65, 0
    v_mov_b32 v17, 0
L_lw28:
    ds_read_b32 v16, v17 offset:12
    s_waitcnt lgkmcnt(0)
    v_readfirstlane_b32 s63, v16
    s_cmp_ge_u32 s63, 1
    s_cbranch_scc1 L_lwd29
    s_add_u32 s65, s65, 1
    s_cmp_gt_u32 s65, 400000
    s_cbranch_scc1 L_end
    s_sleep 1
    s_branch L_lw28
L_lwd29:
    s_lshr_b32 s63, s63, 1
    s_cmp_gt_u32 s63, s69
    s_cbranch_scc0 L_wo_b2d
    s_mov_b32 s69, 1
    s_movk_i32 s63, 9216
    s_lshl_b32 s64, s32, 7
    s_sub_u32 s64, 1024, s64
    buffer_load_dwordx4 a[32:35], v13, s[48:51], s64 offen nt
    s_add_u32 s64, s64, s63
    buffer_load_dwordx4 a[36:39], v13, s[48:51], s64 offen nt
    s_add_u32 s64, s64, s63
    buffer_load_dwordx4 a[40:43], v13, s[48:51], s64 offen nt
    s_add_u32 s64, s64, s63
    buffer_load_dwordx4 a[44:47], v13, s[48:51], s64 offen nt
    s_add_u32 s64, s64, s63
    buffer_load_dwordx4 a[48:51], v13, s[48:51], s64 offen nt
    s_add_u32 s64, s64, s63
    buffer_load_dwordx4 a[52:55], v13, s[48:51], s64 offen nt
    s_add_u32 s64, s64, s63
    buffer_load_dwordx4 a[56:59], v13, s[48:51], s64 offen nt
    s_add_u32 s64, s64, s63
    buffer_load_dwordx4 a[60:63], v13, s[48:51], s64 offen nt
    s_add_u32 s64, s64, s63
L_wo_b2d:
    v_mov_b32 v22, 0
    v_mov_b32 v23, 1
    s_mov_b32 s65, 0
L_pl30:
    buffer_load_dwordx4 v[32:35], v1, s[44:47], 0 offen sc1 nt
    buffer_load_dwordx4 v[36:39], v1, s[44:47], 0 offen offset:128 sc1 nt
    s_add_u32 s65, s65, 1
    s_cmp_gt_u32 s65, 20000
    s_cbranch_scc1 L_end
    s_waitcnt vmcnt(0)
    v_xor_b32 v32, s57, v32
    v_xor_b32 v33, s58, v33
    v_xor_b32 v34, s59, v34
    v_xor_b32 v35, s60, v35
    v_or3_b32 v6, v32, v33, v34
    v_or_b32 v6, v6, v35
    v_xor_b32 v36, s57, v36
    v_xor_b32 v37, s58, v37
    v_xor_b32 v38, s59, v38
    v_xor_b32 v39, s60, v39
    v_or3_b32 v6, v6, v36, v37
    v_or3_b32 v6, v6, v38, v39
    v_and_b32 v6, 0xff, v6
    v_cmp_ne_u32 vcc, 0, v6
    s_cbranch_vccz L_pld31
    s_mov_b64 exec, vcc
    s_branch L_pl30
L_pld31:
    s_mov_b64 exec, -1
    v_add_f32_dpp v32, v32, v32 quad_perm:[1,0,3,2] row_mask:0xf bank_mask:0xf
    v_add_f32_dpp v33, v33, v33 quad_perm:[1,0,3,2] row_mask:0xf bank_mask:0xf
    v_add_f32_dpp v34, v34, v34 quad_perm:[1,0,3,2] row_mask:0xf bank_mask:0xf
    v_add_f32_dpp v35, v35, v35 quad_perm:[1,0,3,2] row_mask:0xf bank_mask:0xf
    v_add_f32_dpp v36, v36, v36 quad_perm:[1,0,3,2] row_mask:0xf bank_mask:0xf
    v_add_f32_dpp v37, v37, v37 quad_perm:[1,0,3,2] row_mask:0xf bank_mask:0xf
    v_add_f32_dpp v38, v38, v38 quad_perm:[1,0,3,2] row_mask:0xf bank_mask:0xf
    v_add_f32_dpp v39, v39, v39 quad_perm:[1,0,3,2] row_mask:0xf bank_mask:0xf
    v_add_f32_dpp v32, v32, v32 quad_perm:[2,3,0,1] row_mask:0xf bank_mask:0xf
    v_add_f32_dpp v33, v33, v33 quad_perm:[2,3,0,1] row_mask:0xf bank_mask:0xf
    v_add_f32_dpp v34, v34, v34 quad_perm:[2,3,0,1] row_mask:0xf bank_mask:0xf
    v_add_f32_dpp v35, v35, v35 quad_perm:[2,3,0,1] row_mask:0xf bank_mask:0xf
    v_add_f32_dpp v36, v36, v36 quad_perm:[2,3,0,1] row_mask:0xf bank_mask:0xf
    v_add_f32_dpp v37, v37, v37 quad_perm:[2,3,0,1] row_mask:0xf bank_mask:0xf
    v_add_f32_dpp v38, v38, v38 quad_perm:[2,3,0,1] row_mask:0xf bank_mask:0xf
    v_add_f32_dpp v39, v39, v39 quad_perm:[2,3,0,1] row_mask:0xf bank_mask:0xf
    v_add_f32_dpp v32, v32, v32 row_half_mirror row_mask:0xf bank_mask:0xf
    v_add_f32_dpp v33, v33, v33 row_half_mirror row_mask:0xf bank_mask:0xf
    v_add_f32_dpp v34, v34, v34 row_half_mirror row_mask:0xf bank_mask:0xf
    v_add_f32_dpp v35, v35, v35 row_half_mirror row_mask:0xf bank_mask:0xf
    v_add_f32_dpp v36, v36, v36 row_half_mirror row_mask:0xf bank_mask:0xf
    v_add_f32_dpp v37, v37, v37 row_half_mirror row_mask:0xf bank_mask:0xf
    v_add_f32_dpp v38, v38, v38 row_half_mirror row_mask:0xf bank_mask:0xf
    v_add_f32_dpp v39, v39, v39 row_half_mirror row_mask:0xf bank_mask:0xf
    v_cvt_pk_bf16_f32 v32, v32, v32
    v_cvt_pk_bf16_f32 v33, v33, v33
    v_cvt_pk_bf16_f32 v34, v34, v34
    v_cvt_pk_bf16_f32 v35, v35, v35
    v_cvt_pk_bf16_f32 v36, v36, v36
    v_cvt_pk_bf16_f32 v37, v37, v37
    v_cvt_pk_bf16_f32 v38, v38, v38
    v_cvt_pk_bf16_f32 v39, v39, v39
    v_and_b32 v48, v32, v8
    v_and_b32 v49, v32, v9
    v_and_b32 v50, v32, v10
    v_and_b32 v51, v32, v11
    v_and_b32 v52, v33, v8
    v_and_b32 v53, v33, v9
    v_and_b32 v54, v33, v10
    v_and_b32 v55, v33, v11
    s_cmp_lg_u32 s69, 0
    s_cbranch_scc1 L_wo_two
    v_mfma_f32_16x16x32_bf16 v[4:7], v[48:51], a[0:3], 0
    v_and_b32 v56, v34, v8
    v_and_b32 v57, v34, v9
    v_and_b32 v58, v34, v10
    v_and_b32 v59, v34, v11
    v_mfma_f32_16x16x32_bf16 v[4:7], v[52:55], a[4:7], v[4:7]
    v_and_b32 v60, v35, v8
    v_and_b32 v61, v35, v9
    v_and_b32 v62, v35, v10
    v_and_b32 v63, v35, v11
    v_mfma_f32_16x16x32_bf16 v[4:7], v[56:59], a[8:11], v[4:7]
    v_and_b32 v64, v36, v8
    v_and_b32 v65, v36, v9
    v_and_b32 v66, v36, v10
    v_and_b32 v67, v36, v11
    v_mfma_f32_16x16x32_bf16 v[4:7], v[60:63], a[12:15], v[4:7]
    v_and_b32 v68, v37, v8
    v_and_b32 v69, v37, v9
    v_and_b32 v70, v37, v10
    v_and_b32 v71, v37, v11
    v_mfma_f32_16x16x32_bf16 v[4:7], v[64:67], a[16:19], v[4:7]
    v_and_b32 v72, v38, v8
    v_and_b32 v73, v38, v9
    v_and_b32 v74, v38, v10
    v_and_b32 v75, v38, v11
    v_mfma_f32_16x16x32_bf16 v[4:7], v[68:71], a[20:23], v[4:7]
    v_and_b32 v76, v39, v8
    v_and_b32 v77, v39, v9
    v_and_b32 v78, v39, v10
    v_and_b32 v79, v39, v11
    v_mfma_f32_16x16x32_bf16 v[4:7], v[72:75], a[24:27], v[4:7]
    s_nop 0
    v_mfma_f32_16x16x32_bf16 v[4:7], v[76:79], a[28:31], v[4:7]
    s_mov_b64 exec, s[66:67]
    s_nop 6
L_wo_one:
    ds_write_b128 v3, v[4:7] offset:11264
    s_mov_b64 exec, 1
    ds_add_u32 v22, v23 offset:32
    s_mov_b64 exec, -1
    s_cmp_eq_u32 s3, 0
    s_cbranch_scc1 L_wo_red
    s_cmp_eq_u32 s3, 2
    s_cbranch_scc1 L_h2_end
    s_cmp_lg_u32 s3, 1
    s_cbranch_scc1 L_h_done
    s_cmp_eq_u32 s69, 0
    s_cbranch_scc1 L_h_done
L_wo_red:
    ds_read_b32 v21, v22 offset:32
    ds_read2st64_b32 v[4:5], v14 offset0:44 offset1:45
    ds_read2st64_b32 v[6:7], v14 offset0:46 offset1:47
    ds_read2st64_b32 v[8:9], v14 offset0:48 offset1:49
    ds_read2st64_b32 v[10:11], v14 offset0:50 offset1:51
    s_add_u32 s65, s65, 1
    s_cmp_gt_u32 s65, 400000
    s_cbranch_scc1 L_end
    s_waitcnt lgkmcnt(4)
    v_cmp_ne_u32 vcc, 4, v21
    s_cbranch_vccnz L_wo_red
    s_waitcnt lgkmcnt(2)
    v_pk_add_f32 v[4:5], v[4:5], v[6:7]
    s_waitcnt lgkmcnt(0)
    v_pk_add_f32 v[8:9], v[8:9], v[10:11]
    v_pk_add_f32 v[4:5], v[4:5], v[8:9]
    v_add_f32 v4, v4, v5
    v_and_or_b32 v4, v4, v12, v20
    buffer_store_dword v4, v15, s[44:47], 0 offen sc1
L_h_done:
L_end:
    s_endpgm
L_h2_end:
    s_cmp_eq_u32 s2, 8
    s_cbranch_scc1 L_fin_h2
    s_cmp_eq_u32 s2, 76
    s_cbranch_scc1 L_fin_h2
    s_branch L_h_done
L_wo_two:
    v_mfma_f32_16x16x32_bf16 v[4:7], v[48:51], a[0:3], 0
    v_mfma_f32_16x16x32_bf16 v[16:19], v[48:51], a[32:35], 0
    v_and_b32 v56, v34, v8
    v_and_b32 v57, v34, v9
    v_and_b32 v58, v34, v10
    v_and_b32 v59, v34, v11
    v_mfma_f32_16x16x32_bf16 v[4:7], v[52:55], a[4:7], v[4:7]
    v_mfma_f32_16x16x32_bf16 v[16:19], v[52:55], a[36:39], v[16:19]
    v_and_b32 v60, v35, v8
    v_and_b32 v61, v35, v9
    v_and_b32 v62, v35, v10
    v_and_b32 v63, v35, v11
    v_mfma_f32_16x16x32_bf16 v[4:7], v[56:59], a[8:11], v[4:7]
    v_mfma_f32_16x16x32_bf16 v[16:19], v[56:59], a[40:43], v[16:19]
    v_and_b32 v64, v36, v8
    v_and_b32 v65, v36, v9
    v_and_b32 v66, v36, v10
    v_and_b32 v67, v36, v11
    v_mfma_f32_16x16x32_bf16 v[4:7], v[60:63], a[12:15], v[4:7]
    v_mfma_f32_16x16x32_bf16 v[16:19], v[60:63], a[44:47], v[16:19]
    v_and_b32 v68, v37, v8
    v_and_b32 v69, v37, v9
    v_and_b32 v70, v37, v10
    v_and_b32 v71, v37, v11
    v_mfma_f32_16x16x32_bf16 v[4:7], v[64:67], a[16:19], v[4:7]
    v_mfma_f32_16x16x32_bf16 v[16:19], v[64:67], a[48:51], v[16:19]
    v_and_b32 v72, v38, v8
    v_and_b32 v73, v38, v9
    v_and_b32 v74, v38, v10
    v_and_b32 v75, v38, v11
    v_mfma_f32_16x16x32_bf16 v[4:7], v[68:71], a[20:23], v[4:7]
    v_mfma_f32_16x16x32_bf16 v[16:19], v[68:71], a[52:55], v[16:19]
    v_and_b32 v76, v39, v8
    v_and_b32 v77, v39, v9
    v_and_b32 v78, v39, v10
    v_and_b32 v79, v39, v11
    v_mfma_f32_16x16x32_bf16 v[4:7], v[72:75], a[24:27], v[4:7]
    v_mfma_f32_16x16x32_bf16 v[16:19], v[72:75], a[56:59], v[16:19]
    v_mfma_f32_16x16x32_bf16 v[4:7], v[76:79], a[28:31], v[4:7]
    v_mfma_f32_16x16x32_bf16 v[16:19], v[76:79], a[60:63], v[16:19]
    s_mov_b64 exec, s[66:67]
    s_nop 7
    ds_write_b128 v3, v[16:19] offset:13312
    s_branch L_wo_one
L_repub:
    s_mov_b32 s69, 1
    s_mov_b32 s89, s65
    s_mov_b64 s[94:95], exec
    s_mov_b64 exec, -1
    v_lshlrev_b32 v3, 4, v0
    s_lshl_b32 s63, s34, 10
    s_add_u32 s63, s63, 65536
    v_add_u32 v3, s63, v3
    s_lshl_b32 s63, s34, 4
    s_add_u32 s63, s63, 327680
    v_mov_b32 v7, s63
    s_mov_b32 s65, 0
L_pl32:
    buffer_load_dwordx4 v[68:71], v3, s[44:47], 0 offen sc1
    buffer_load_dwordx4 v[72:75], v7, s[44:47], 0 offen sc1
    s_add_u32 s65, s65, 1
    s_cmp_gt_u32 s65, 20000
    s_cbranch_scc1 L_end
    s_waitcnt vmcnt(0)
    v_xor_b32 v68, s57, v68
    v_xor_b32 v69, s58, v69
    v_xor_b32 v70, s59, v70
    v_xor_b32 v71, s60, v71
    v_or3_b32 v6, v68, v69, v70
    v_or_b32 v6, v6, v71
    v_xor_b32 v72, s57, v72
    v_xor_b32 v73, s58, v73
    v_xor_b32 v74, s59, v74
    v_xor_b32 v75, s60, v75
    v_or3_b32 v6, v6, v72, v73
    v_or3_b32 v6, v6, v74, v75
    v_and_b32 v6, 0xff, v6
    v_cmp_ne_u32 vcc, 0, v6
    s_cbranch_vccz L_pld33
    s_mov_b64 exec, vcc
    s_branch L_pl32
L_pld33:
    s_mov_b64 exec, -1
    v_and_or_b32 v68, v68, v12, s57
    v_and_or_b32 v69, v69, v12, s58
    v_and_or_b32 v70, v70, v12, s59
    v_and_or_b32 v71, v71, v12, s60
    v_and_or_b32 v72, v72, v12, s57
    v_and_or_b32 v73, v73, v12, s58
    v_and_or_b32 v74, v74, v12, s59
    v_and_or_b32 v75, v75, v12, s60
    buffer_store_dwordx4 v[68:71], v3, s[44:47], 0 offen sc1
    s_mov_b64 exec, 1
    buffer_store_dwordx4 v[72:75], v7, s[44:47], 0 offen sc1
    s_mov_b64 exec, s[94:95]
    s_mov_b32 s65, s89
    s_setpc_b64 s[90:91]
L_direct:
    s_waitcnt lgkmcnt(0)
    s_load_dword s68, s[22:23], 0
    v_mul_u32_u24 v4, 144, v0
    s_mov_b32 s48, s16
    s_and_b32 s49, s17, 0xffff
    s_mov_b32 s50, 9216
    s_mov_b32 s51, 0x20000
    buffer_load_dwordx4 a[0:3], v4, s[48:51], 0 offen offset:0
    buffer_load_dwordx4 a[4:7], v4, s[48:51], 0 offen offset:16
    buffer_load_dwordx4 a[8:11], v4, s[48:51], 0 offen offset:32
    buffer_load_dwordx4 a[12:15], v4, s[48:51], 0 offen offset:48
    buffer_load_dwordx4 a[16:19], v4, s[48:51], 0 offen offset:64
    buffer_load_dwordx4 a[20:23], v4, s[48:51], 0 offen offset:80
    buffer_load_dwordx4 a[24:27], v4, s[48:51], 0 offen offset:96
    buffer_load_dwordx4 a[28:31], v4, s[48:51], 0 offen offset:112
    buffer_load_dwordx4 a[32:35], v4, s[48:51], 0 offen offset:128
    s_mov_b32 s48, s18
    s_nop 0
    s_and_b32 s49, s19, 0xffff
    s_mov_b32 s50, 9216
    s_mov_b32 s51, 0x20000
    buffer_load_dwordx4 a[36:39], v4, s[48:51], 0 offen offset:0
    buffer_load_dwordx4 a[40:43], v4, s[48:51], 0 offen offset:16
    buffer_load_dwordx4 a[44:47], v4, s[48:51], 0 offen offset:32
    buffer_load_dwordx4 a[48:51], v4, s[48:51], 0 offen offset:48
    buffer_load_dwordx4 a[52:55], v4, s[48:51], 0 offen offset:64
    buffer_load_dwordx4 a[56:59], v4, s[48:51], 0 offen offset:80
    buffer_load_dwordx4 a[60:63], v4, s[48:51], 0 offen offset:96
    buffer_load_dwordx4 a[64:67], v4, s[48:51], 0 offen offset:112
    buffer_load_dwordx4 a[68:71], v4, s[48:51], 0 offen offset:128
    s_mov_b32 s48, s20
    s_nop 0
    s_and_b32 s49, s21, 0xffff
    s_mov_b32 s50, 9216
    s_mov_b32 s51, 0x20000
    buffer_load_dwordx4 a[72:75], v4, s[48:51], 0 offen offset:0
    buffer_load_dwordx4 a[76:79], v4, s[48:51], 0 offen offset:16
    buffer_load_dwordx4 a[80:83], v4, s[48:51], 0 offen offset:32
    buffer_load_dwordx4 a[84:87], v4, s[48:51], 0 offen offset:48
    buffer_load_dwordx4 a[88:91], v4, s[48:51], 0 offen offset:64
    buffer_load_dwordx4 a[92:95], v4, s[48:51], 0 offen offset:80
    buffer_load_dwordx4 a[96:99], v4, s[48:51], 0 offen offset:96
    buffer_load_dwordx4 a[100:103], v4, s[48:51], 0 offen offset:112
    buffer_load_dwordx4 a[104:107], v4, s[48:51], 0 offen offset:128
    s_waitcnt vmcnt(0) lgkmcnt(0)
    s_lshl_b32 s68, s68, 16
    v_cmp_le_u32 vcc, 20480, v14
    s_mov_b64 s[66:67], vcc
L_fb34:
    s_cmp_eq_u64 s[66:67], 0
    s_cbranch_scc1 L_fbd35
    s_ff1_i32_b64 s63, s[66:67]
    s_bitset0_b64 s[66:67], s63
    v_readlane_b32 s64, v6, s63
    s_lshl_b32 s64, s64, 16
    s_getpc_b64 s[90:91]
    s_add_u32 s90, s90, 12
    s_addc_u32 s91, s91, 0
    s_branch L_eval
    v_cmp_eq_u32 vcc, s63, v0
    s_nop 1
    v_cndmask_b32 v24, v24, v40, vcc
    s_branch L_fb34
L_fbd35:
    v_cmp_le_u32 vcc, 20480, v15
    s_mov_b64 s[66:67], vcc
L_fb36:
    s_cmp_eq_u64 s[66:67], 0
    s_cbranch_scc1 L_fbd37
    s_ff1_i32_b64 s63, s[66:67]
    s_bitset0_b64 s[66:67], s63
    v_readlane_b32 s64, v6, s63
    s_and_b32 s64, s64, 0xffff0000
    s_getpc_b64 s[90:91]
    s_add_u32 s90, s90, 12
    s_addc_u32 s91, s91, 0
    s_branch L_eval
    v_cmp_eq_u32 vcc, s63, v0
    s_nop 1
    v_cndmask_b32 v25, v25, v40, vcc
    s_branch L_fb36
L_fbd37:
    v_cmp_le_u32 vcc, 20480, v16
    s_mov_b64 s[66:67], vcc
L_fb38:
    s_cmp_eq_u64 s[66:67], 0
    s_cbranch_scc1 L_fbd39
    s_ff1_i32_b64 s63, s[66:67]
    s_bitset0_b64 s[66:67], s63
    v_readlane_b32 s64, v7, s63
    s_lshl_b32 s64, s64, 16
    s_getpc_b64 s[90:91]
    s_add_u32 s90, s90, 12
    s_addc_u32 s91, s91, 0
    s_branch L_eval
    v_cmp_eq_u32 vcc, s63, v0
    s_nop 1
    v_cndmask_b32 v26, v26, v40, vcc
    s_branch L_fb38
L_fbd39:
    s_branch L_fin_out
L_eval:
    v_mov_b32 v40, 0
    v_mov_b32 v48, 0xc0135761
    v_accvgpr_read_b32 v41, a0
    v_accvgpr_read_b32 v42, a36
    v_accvgpr_read_b32 v43, a72
    v_lshlrev_b32 v44, 16, v41
    v_lshlrev_b32 v45, 16, v42
    v_lshlrev_b32 v46, 16, v43
    v_fma_f32 v44, s64, v44, v45
    v_mul_f32 v45, v44, v44
    v_fmamk_f32 v45, v45, 0xbdd2d3e8, v48
    v_mul_f32 v45, v45, v44
    v_exp_f32 v45, v45
    s_nop 0
    v_add_f32 v45, 1.0, v45
    v_rcp_f32 v45, v45
    s_nop 0
    v_mul_f32 v44, v44, v45
    v_fmac_f32 v40, v44, v46
    v_and_b32 v44, 0xffff0000, v41
    v_and_b32 v45, 0xffff0000, v42
    v_and_b32 v46, 0xffff0000, v43
    v_fma_f32 v44, s64, v44, v45
    v_mul_f32 v45, v44, v44
    v_fmamk_f32 v45, v45, 0xbdd2d3e8, v48
    v_mul_f32 v45, v45, v44
    v_exp_f32 v45, v45
    s_nop 0
    v_add_f32 v45, 1.0, v45
    v_rcp_f32 v45, v45
    s_nop 0
    v_mul_f32 v44, v44, v45
    v_fmac_f32 v40, v44, v46
    v_accvgpr_read_b32 v41, a1
    v_accvgpr_read_b32 v42, a37
    v_accvgpr_read_b32 v43, a73
    v_lshlrev_b32 v44, 16, v41
    v_lshlrev_b32 v45, 16, v42
    v_lshlrev_b32 v46, 16, v43
    v_fma_f32 v44, s64, v44, v45
    v_mul_f32 v45, v44, v44
    v_fmamk_f32 v45, v45, 0xbdd2d3e8, v48
    v_mul_f32 v45, v45, v44
    v_exp_f32 v45, v45
    s_nop 0
    v_add_f32 v45, 1.0, v45
    v_rcp_f32 v45, v45
    s_nop 0
    v_mul_f32 v44, v44, v45
    v_fmac_f32 v40, v44, v46
    v_and_b32 v44, 0xffff0000, v41
    v_and_b32 v45, 0xffff0000, v42
    v_and_b32 v46, 0xffff0000, v43
    v_fma_f32 v44, s64, v44, v45
    v_mul_f32 v45, v44, v44
    v_fmamk_f32 v45, v45, 0xbdd2d3e8, v48
    v_mul_f32 v45, v45, v44
    v_exp_f32 v45, v45
    s_nop 0
    v_add_f32 v45, 1.0, v45
    v_rcp_f32 v45, v45
    s_nop 0
    v_mul_f32 v44, v44, v45
    v_fmac_f32 v40, v44, v46
    v_accvgpr_read_b32 v41, a2
    v_accvgpr_read_b32 v42, a38
    v_accvgpr_read_b32 v43, a74
    v_lshlrev_b32 v44, 16, v41
    v_lshlrev_b32 v45, 16, v42
    v_lshlrev_b32 v46, 16, v43
    v_fma_f32 v44, s64, v44, v45
    v_mul_f32 v45, v44, v44
    v_fmamk_f32 v45, v45, 0xbdd2d3e8, v48
    v_mul_f32 v45, v45, v44
    v_exp_f32 v45, v45
    s_nop 0
    v_add_f32 v45, 1.0, v45
    v_rcp_f32 v45, v45
    s_nop 0
    v_mul_f32 v44, v44, v45
    v_fmac_f32 v40, v44, v46
    v_and_b32 v44, 0xffff0000, v41
    v_and_b32 v45, 0xffff0000, v42
    v_and_b32 v46, 0xffff0000, v43
    v_fma_f32 v44, s64, v44, v45
    v_mul_f32 v45, v44, v44
    v_fmamk_f32 v45, v45, 0xbdd2d3e8, v48
    v_mul_f32 v45, v45, v44
    v_exp_f32 v45, v45
    s_nop 0
    v_add_f32 v45, 1.0, v45
    v_rcp_f32 v45, v45
    s_nop 0
    v_mul_f32 v44, v44, v45
    v_fmac_f32 v40, v44, v46
    v_accvgpr_read_b32 v41, a3
    v_accvgpr_read_b32 v42, a39
    v_accvgpr_read_b32 v43, a75
    v_lshlrev_b32 v44, 16, v41
    v_lshlrev_b32 v45, 16, v42
    v_lshlrev_b32 v46, 16, v43
    v_fma_f32 v44, s64, v44, v45
    v_mul_f32 v45, v44, v44
    v_fmamk_f32 v45, v45, 0xbdd2d3e8, v48
    v_mul_f32 v45, v45, v44
    v_exp_f32 v45, v45
    s_nop 0
    v_add_f32 v45, 1.0, v45
    v_rcp_f32 v45, v45
    s_nop 0
    v_mul_f32 v44, v44, v45
    v_fmac_f32 v40, v44, v46
    v_and_b32 v44, 0xffff0000, v41
    v_and_b32 v45, 0xffff0000, v42
    v_and_b32 v46, 0xffff0000, v43
    v_fma_f32 v44, s64, v44, v45
    v_mul_f32 v45, v44, v44
    v_fmamk_f32 v45, v45, 0xbdd2d3e8, v48
    v_mul_f32 v45, v45, v44
    v_exp_f32 v45, v45
    s_nop 0
    v_add_f32 v45, 1.0, v45
    v_rcp_f32 v45, v45
    s_nop 0
    v_mul_f32 v44, v44, v45
    v_fmac_f32 v40, v44, v46
    v_accvgpr_read_b32 v41, a4
    v_accvgpr_read_b32 v42, a40
    v_accvgpr_read_b32 v43, a76
    v_lshlrev_b32 v44, 16, v41
    v_lshlrev_b32 v45, 16, v42
    v_lshlrev_b32 v46, 16, v43
    v_fma_f32 v44, s64, v44, v45
    v_mul_f32 v45, v44, v44
    v_fmamk_f32 v45, v45, 0xbdd2d3e8, v48
    v_mul_f32 v45, v45, v44
    v_exp_f32 v45, v45
    s_nop 0
    v_add_f32 v45, 1.0, v45
    v_rcp_f32 v45, v45
    s_nop 0
    v_mul_f32 v44, v44, v45
    v_fmac_f32 v40, v44, v46
    v_and_b32 v44, 0xffff0000, v41
    v_and_b32 v45, 0xffff0000, v42
    v_and_b32 v46, 0xffff0000, v43
    v_fma_f32 v44, s64, v44, v45
    v_mul_f32 v45, v44, v44
    v_fmamk_f32 v45, v45, 0xbdd2d3e8, v48
    v_mul_f32 v45, v45, v44
    v_exp_f32 v45, v45
    s_nop 0
    v_add_f32 v45, 1.0, v45
    v_rcp_f32 v45, v45
    s_nop 0
    v_mul_f32 v44, v44, v45
    v_fmac_f32 v40, v44, v46
    v_accvgpr_read_b32 v41, a5
    v_accvgpr_read_b32 v42, a41
    v_accvgpr_read_b32 v43, a77
    v_lshlrev_b32 v44, 16, v41
    v_lshlrev_b32 v45, 16, v42
    v_lshlrev_b32 v46, 16, v43
    v_fma_f32 v44, s64, v44, v45
    v_mul_f32 v45, v44, v44
    v_fmamk_f32 v45, v45, 0xbdd2d3e8, v48
    v_mul_f32 v45, v45, v44
    v_exp_f32 v45, v45
    s_nop 0
    v_add_f32 v45, 1.0, v45
    v_rcp_f32 v45, v45
    s_nop 0
    v_mul_f32 v44, v44, v45
    v_fmac_f32 v40, v44, v46
    v_and_b32 v44, 0xffff0000, v41
    v_and_b32 v45, 0xffff0000, v42
    v_and_b32 v46, 0xffff0000, v43
    v_fma_f32 v44, s64, v44, v45
    v_mul_f32 v45, v44, v44
    v_fmamk_f32 v45, v45, 0xbdd2d3e8, v48
    v_mul_f32 v45, v45, v44
    v_exp_f32 v45, v45
    s_nop 0
    v_add_f32 v45, 1.0, v45
    v_rcp_f32 v45, v45
    s_nop 0
    v_mul_f32 v44, v44, v45
    v_fmac_f32 v40, v44, v46
    v_accvgpr_read_b32 v41, a6
    v_accvgpr_read_b32 v42, a42
    v_accvgpr_read_b32 v43, a78
    v_lshlrev_b32 v44, 16, v41
    v_lshlrev_b32 v45, 16, v42
    v_lshlrev_b32 v46, 16, v43
    v_fma_f32 v44, s64, v44, v45
    v_mul_f32 v45, v44, v44
    v_fmamk_f32 v45, v45, 0xbdd2d3e8, v48
    v_mul_f32 v45, v45, v44
    v_exp_f32 v45, v45
    s_nop 0
    v_add_f32 v45, 1.0, v45
    v_rcp_f32 v45, v45
    s_nop 0
    v_mul_f32 v44, v44, v45
    v_fmac_f32 v40, v44, v46
    v_and_b32 v44, 0xffff0000, v41
    v_and_b32 v45, 0xffff0000, v42
    v_and_b32 v46, 0xffff0000, v43
    v_fma_f32 v44, s64, v44, v45
    v_mul_f32 v45, v44, v44
    v_fmamk_f32 v45, v45, 0xbdd2d3e8, v48
    v_mul_f32 v45, v45, v44
    v_exp_f32 v45, v45
    s_nop 0
    v_add_f32 v45, 1.0, v45
    v_rcp_f32 v45, v45
    s_nop 0
    v_mul_f32 v44, v44, v45
    v_fmac_f32 v40, v44, v46
    v_accvgpr_read_b32 v41, a7
    v_accvgpr_read_b32 v42, a43
    v_accvgpr_read_b32 v43, a79
    v_lshlrev_b32 v44, 16, v41
    v_lshlrev_b32 v45, 16, v42
    v_lshlrev_b32 v46, 16, v43
    v_fma_f32 v44, s64, v44, v45
    v_mul_f32 v45, v44, v44
    v_fmamk_f32 v45, v45, 0xbdd2d3e8, v48
    v_mul_f32 v45, v45, v44
    v_exp_f32 v45, v45
    s_nop 0
    v_add_f32 v45, 1.0, v45
    v_rcp_f32 v45, v45
    s_nop 0
    v_mul_f32 v44, v44, v45
    v_fmac_f32 v40, v44, v46
    v_and_b32 v44, 0xffff0000, v41
    v_and_b32 v45, 0xffff0000, v42
    v_and_b32 v46, 0xffff0000, v43
    v_fma_f32 v44, s64, v44, v45
    v_mul_f32 v45, v44, v44
    v_fmamk_f32 v45, v45, 0xbdd2d3e8, v48
    v_mul_f32 v45, v45, v44
    v_exp_f32 v45, v45
    s_nop 0
    v_add_f32 v45, 1.0, v45
    v_rcp_f32 v45, v45
    s_nop 0
    v_mul_f32 v44, v44, v45
    v_fmac_f32 v40, v44, v46
    v_accvgpr_read_b32 v41, a8
    v_accvgpr_read_b32 v42, a44
    v_accvgpr_read_b32 v43, a80
    v_lshlrev_b32 v44, 16, v41
    v_lshlrev_b32 v45, 16, v42
    v_lshlrev_b32 v46, 16, v43
    v_fma_f32 v44, s64, v44, v45
    v_mul_f32 v45, v44, v44
    v_fmamk_f32 v45, v45, 0xbdd2d3e8, v48
    v_mul_f32 v45, v45, v44
    v_exp_f32 v45, v45
    s_nop 0
    v_add_f32 v45, 1.0, v45
    v_rcp_f32 v45, v45
    s_nop 0
    v_mul_f32 v44, v44, v45
    v_fmac_f32 v40, v44, v46
    v_and_b32 v44, 0xffff0000, v41
    v_and_b32 v45, 0xffff0000, v42
    v_and_b32 v46, 0xffff0000, v43
    v_fma_f32 v44, s64, v44, v45
    v_mul_f32 v45, v44, v44
    v_fmamk_f32 v45, v45, 0xbdd2d3e8, v48
    v_mul_f32 v45, v45, v44
    v_exp_f32 v45, v45
    s_nop 0
    v_add_f32 v45, 1.0, v45
    v_rcp_f32 v45, v45
    s_nop 0
    v_mul_f32 v44, v44, v45
    v_fmac_f32 v40, v44, v46
    v_accvgpr_read_b32 v41, a9
    v_accvgpr_read_b32 v42, a45
    v_accvgpr_read_b32 v43, a81
    v_lshlrev_b32 v44, 16, v41
    v_lshlrev_b32 v45, 16, v42
    v_lshlrev_b32 v46, 16, v43
    v_fma_f32 v44, s64, v44, v45
    v_mul_f32 v45, v44, v44
    v_fmamk_f32 v45, v45, 0xbdd2d3e8, v48
    v_mul_f32 v45, v45, v44
    v_exp_f32 v45, v45
    s_nop 0
    v_add_f32 v45, 1.0, v45
    v_rcp_f32 v45, v45
    s_nop 0
    v_mul_f32 v44, v44, v45
    v_fmac_f32 v40, v44, v46
    v_and_b32 v44, 0xffff0000, v41
    v_and_b32 v45, 0xffff0000, v42
    v_and_b32 v46, 0xffff0000, v43
    v_fma_f32 v44, s64, v44, v45
    v_mul_f32 v45, v44, v44
    v_fmamk_f32 v45, v45, 0xbdd2d3e8, v48
    v_mul_f32 v45, v45, v44
    v_exp_f32 v45, v45
    s_nop 0
    v_add_f32 v45, 1.0, v45
    v_rcp_f32 v45, v45
    s_nop 0
    v_mul_f32 v44, v44, v45
    v_fmac_f32 v40, v44, v46
    v_accvgpr_read_b32 v41, a10
    v_accvgpr_read_b32 v42, a46
    v_accvgpr_read_b32 v43, a82
    v_lshlrev_b32 v44, 16, v41
    v_lshlrev_b32 v45, 16, v42
    v_lshlrev_b32 v46, 16, v43
    v_fma_f32 v44, s64, v44, v45
    v_mul_f32 v45, v44, v44
    v_fmamk_f32 v45, v45, 0xbdd2d3e8, v48
    v_mul_f32 v45, v45, v44
    v_exp_f32 v45, v45
    s_nop 0
    v_add_f32 v45, 1.0, v45
    v_rcp_f32 v45, v45
    s_nop 0
    v_mul_f32 v44, v44, v45
    v_fmac_f32 v40, v44, v46
    v_and_b32 v44, 0xffff0000, v41
    v_and_b32 v45, 0xffff0000, v42
    v_and_b32 v46, 0xffff0000, v43
    v_fma_f32 v44, s64, v44, v45
    v_mul_f32 v45, v44, v44
    v_fmamk_f32 v45, v45, 0xbdd2d3e8, v48
    v_mul_f32 v45, v45, v44
    v_exp_f32 v45, v45
    s_nop 0
    v_add_f32 v45, 1.0, v45
    v_rcp_f32 v45, v45
    s_nop 0
    v_mul_f32 v44, v44, v45
    v_fmac_f32 v40, v44, v46
    v_accvgpr_read_b32 v41, a11
    v_accvgpr_read_b32 v42, a47
    v_accvgpr_read_b32 v43, a83
    v_lshlrev_b32 v44, 16, v41
    v_lshlrev_b32 v45, 16, v42
    v_lshlrev_b32 v46, 16, v43
    v_fma_f32 v44, s64, v44, v45
    v_mul_f32 v45, v44, v44
    v_fmamk_f32 v45, v45, 0xbdd2d3e8, v48
    v_mul_f32 v45, v45, v44
    v_exp_f32 v45, v45
    s_nop 0
    v_add_f32 v45, 1.0, v45
    v_rcp_f32 v45, v45
    s_nop 0
    v_mul_f32 v44, v44, v45
    v_fmac_f32 v40, v44, v46
    v_and_b32 v44, 0xffff0000, v41
    v_and_b32 v45, 0xffff0000, v42
    v_and_b32 v46, 0xffff0000, v43
    v_fma_f32 v44, s64, v44, v45
    v_mul_f32 v45, v44, v44
    v_fmamk_f32 v45, v45, 0xbdd2d3e8, v48
    v_mul_f32 v45, v45, v44
    v_exp_f32 v45, v45
    s_nop 0
    v_add_f32 v45, 1.0, v45
    v_rcp_f32 v45, v45
    s_nop 0
    v_mul_f32 v44, v44, v45
    v_fmac_f32 v40, v44, v46
    v_accvgpr_read_b32 v41, a12
    v_accvgpr_read_b32 v42, a48
    v_accvgpr_read_b32 v43, a84
    v_lshlrev_b32 v44, 16, v41
    v_lshlrev_b32 v45, 16, v42
    v_lshlrev_b32 v46, 16, v43
    v_fma_f32 v44, s64, v44, v45
    v_mul_f32 v45, v44, v44
    v_fmamk_f32 v45, v45, 0xbdd2d3e8, v48
    v_mul_f32 v45, v45, v44
    v_exp_f32 v45, v45
    s_nop 0
    v_add_f32 v45, 1.0, v45
    v_rcp_f32 v45, v45
    s_nop 0
    v_mul_f32 v44, v44, v45
    v_fmac_f32 v40, v44, v46
    v_and_b32 v44, 0xffff0000, v41
    v_and_b32 v45, 0xffff0000, v42
    v_and_b32 v46, 0xffff0000, v43
    v_fma_f32 v44, s64, v44, v45
    v_mul_f32 v45, v44, v44
    v_fmamk_f32 v45, v45, 0xbdd2d3e8, v48
    v_mul_f32 v45, v45, v44
    v_exp_f32 v45, v45
    s_nop 0
    v_add_f32 v45, 1.0, v45
    v_rcp_f32 v45, v45
    s_nop 0
    v_mul_f32 v44, v44, v45
    v_fmac_f32 v40, v44, v46
    v_accvgpr_read_b32 v41, a13
    v_accvgpr_read_b32 v42, a49
    v_accvgpr_read_b32 v43, a85
    v_lshlrev_b32 v44, 16, v41
    v_lshlrev_b32 v45, 16, v42
    v_lshlrev_b32 v46, 16, v43
    v_fma_f32 v44, s64, v44, v45
    v_mul_f32 v45, v44, v44
    v_fmamk_f32 v45, v45, 0xbdd2d3e8, v48
    v_mul_f32 v45, v45, v44
    v_exp_f32 v45, v45
    s_nop 0
    v_add_f32 v45, 1.0, v45
    v_rcp_f32 v45, v45
    s_nop 0
    v_mul_f32 v44, v44, v45
    v_fmac_f32 v40, v44, v46
    v_and_b32 v44, 0xffff0000, v41
    v_and_b32 v45, 0xffff0000, v42
    v_and_b32 v46, 0xffff0000, v43
    v_fma_f32 v44, s64, v44, v45
    v_mul_f32 v45, v44, v44
    v_fmamk_f32 v45, v45, 0xbdd2d3e8, v48
    v_mul_f32 v45, v45, v44
    v_exp_f32 v45, v45
    s_nop 0
    v_add_f32 v45, 1.0, v45
    v_rcp_f32 v45, v45
    s_nop 0
    v_mul_f32 v44, v44, v45
    v_fmac_f32 v40, v44, v46
    v_accvgpr_read_b32 v41, a14
    v_accvgpr_read_b32 v42, a50
    v_accvgpr_read_b32 v43, a86
    v_lshlrev_b32 v44, 16, v41
    v_lshlrev_b32 v45, 16, v42
    v_lshlrev_b32 v46, 16, v43
    v_fma_f32 v44, s64, v44, v45
    v_mul_f32 v45, v44, v44
    v_fmamk_f32 v45, v45, 0xbdd2d3e8, v48
    v_mul_f32 v45, v45, v44
    v_exp_f32 v45, v45
    s_nop 0
    v_add_f32 v45, 1.0, v45
    v_rcp_f32 v45, v45
    s_nop 0
    v_mul_f32 v44, v44, v45
    v_fmac_f32 v40, v44, v46
    v_and_b32 v44, 0xffff0000, v41
    v_and_b32 v45, 0xffff0000, v42
    v_and_b32 v46, 0xffff0000, v43
    v_fma_f32 v44, s64, v44, v45
    v_mul_f32 v45, v44, v44
    v_fmamk_f32 v45, v45, 0xbdd2d3e8, v48
    v_mul_f32 v45, v45, v44
    v_exp_f32 v45, v45
    s_nop 0
    v_add_f32 v45, 1.0, v45
    v_rcp_f32 v45, v45
    s_nop 0
    v_mul_f32 v44, v44, v45
    v_fmac_f32 v40, v44, v46
    v_accvgpr_read_b32 v41, a15
    v_accvgpr_read_b32 v42, a51
    v_accvgpr_read_b32 v43, a87
    v_lshlrev_b32 v44, 16, v41
    v_lshlrev_b32 v45, 16, v42
    v_lshlrev_b32 v46, 16, v43
    v_fma_f32 v44, s64, v44, v45
    v_mul_f32 v45, v44, v44
    v_fmamk_f32 v45, v45, 0xbdd2d3e8, v48
    v_mul_f32 v45, v45, v44
    v_exp_f32 v45, v45
    s_nop 0
    v_add_f32 v45, 1.0, v45
    v_rcp_f32 v45, v45
    s_nop 0
    v_mul_f32 v44, v44, v45
    v_fmac_f32 v40, v44, v46
    v_and_b32 v44, 0xffff0000, v41
    v_and_b32 v45, 0xffff0000, v42
    v_and_b32 v46, 0xffff0000, v43
    v_fma_f32 v44, s64, v44, v45
    v_mul_f32 v45, v44, v44
    v_fmamk_f32 v45, v45, 0xbdd2d3e8, v48
    v_mul_f32 v45, v45, v44
    v_exp_f32 v45, v45
    s_nop 0
    v_add_f32 v45, 1.0, v45
    v_rcp_f32 v45, v45
    s_nop 0
    v_mul_f32 v44, v44, v45
    v_fmac_f32 v40, v44, v46
    v_accvgpr_read_b32 v41, a16
    v_accvgpr_read_b32 v42, a52
    v_accvgpr_read_b32 v43, a88
    v_lshlrev_b32 v44, 16, v41
    v_lshlrev_b32 v45, 16, v42
    v_lshlrev_b32 v46, 16, v43
    v_fma_f32 v44, s64, v44, v45
    v_mul_f32 v45, v44, v44
    v_fmamk_f32 v45, v45, 0xbdd2d3e8, v48
    v_mul_f32 v45, v45, v44
    v_exp_f32 v45, v45
    s_nop 0
    v_add_f32 v45, 1.0, v45
    v_rcp_f32 v45, v45
    s_nop 0
    v_mul_f32 v44, v44, v45
    v_fmac_f32 v40, v44, v46
    v_and_b32 v44, 0xffff0000, v41
    v_and_b32 v45, 0xffff0000, v42
    v_and_b32 v46, 0xffff0000, v43
    v_fma_f32 v44, s64, v44, v45
    v_mul_f32 v45, v44, v44
    v_fmamk_f32 v45, v45, 0xbdd2d3e8, v48
    v_mul_f32 v45, v45, v44
    v_exp_f32 v45, v45
    s_nop 0
    v_add_f32 v45, 1.0, v45
    v_rcp_f32 v45, v45
    s_nop 0
    v_mul_f32 v44, v44, v45
    v_fmac_f32 v40, v44, v46
    v_accvgpr_read_b32 v41, a17
    v_accvgpr_read_b32 v42, a53
    v_accvgpr_read_b32 v43, a89
    v_lshlrev_b32 v44, 16, v41
    v_lshlrev_b32 v45, 16, v42
    v_lshlrev_b32 v46, 16, v43
    v_fma_f32 v44, s64, v44, v45
    v_mul_f32 v45, v44, v44
    v_fmamk_f32 v45, v45, 0xbdd2d3e8, v48
    v_mul_f32 v45, v45, v44
    v_exp_f32 v45, v45
    s_nop 0
    v_add_f32 v45, 1.0, v45
    v_rcp_f32 v45, v45
    s_nop 0
    v_mul_f32 v44, v44, v45
    v_fmac_f32 v40, v44, v46
    v_and_b32 v44, 0xffff0000, v41
    v_and_b32 v45, 0xffff0000, v42
    v_and_b32 v46, 0xffff0000, v43
    v_fma_f32 v44, s64, v44, v45
    v_mul_f32 v45, v44, v44
    v_fmamk_f32 v45, v45, 0xbdd2d3e8, v48
    v_mul_f32 v45, v45, v44
    v_exp_f32 v45, v45
    s_nop 0
    v_add_f32 v45, 1.0, v45
    v_rcp_f32 v45, v45
    s_nop 0
    v_mul_f32 v44, v44, v45
    v_fmac_f32 v40, v44, v46
    v_accvgpr_read_b32 v41, a18
    v_accvgpr_read_b32 v42, a54
    v_accvgpr_read_b32 v43, a90
    v_lshlrev_b32 v44, 16, v41
    v_lshlrev_b32 v45, 16, v42
    v_lshlrev_b32 v46, 16, v43
    v_fma_f32 v44, s64, v44, v45
    v_mul_f32 v45, v44, v44
    v_fmamk_f32 v45, v45, 0xbdd2d3e8, v48
    v_mul_f32 v45, v45, v44
    v_exp_f32 v45, v45
    s_nop 0
    v_add_f32 v45, 1.0, v45
    v_rcp_f32 v45, v45
    s_nop 0
    v_mul_f32 v44, v44, v45
    v_fmac_f32 v40, v44, v46
    v_and_b32 v44, 0xffff0000, v41
    v_and_b32 v45, 0xffff0000, v42
    v_and_b32 v46, 0xffff0000, v43
    v_fma_f32 v44, s64, v44, v45
    v_mul_f32 v45, v44, v44
    v_fmamk_f32 v45, v45, 0xbdd2d3e8, v48
    v_mul_f32 v45, v45, v44
    v_exp_f32 v45, v45
    s_nop 0
    v_add_f32 v45, 1.0, v45
    v_rcp_f32 v45, v45
    s_nop 0
    v_mul_f32 v44, v44, v45
    v_fmac_f32 v40, v44, v46
    v_accvgpr_read_b32 v41, a19
    v_accvgpr_read_b32 v42, a55
    v_accvgpr_read_b32 v43, a91
    v_lshlrev_b32 v44, 16, v41
    v_lshlrev_b32 v45, 16, v42
    v_lshlrev_b32 v46, 16, v43
    v_fma_f32 v44, s64, v44, v45
    v_mul_f32 v45, v44, v44
    v_fmamk_f32 v45, v45, 0xbdd2d3e8, v48
    v_mul_f32 v45, v45, v44
    v_exp_f32 v45, v45
    s_nop 0
    v_add_f32 v45, 1.0, v45
    v_rcp_f32 v45, v45
    s_nop 0
    v_mul_f32 v44, v44, v45
    v_fmac_f32 v40, v44, v46
    v_and_b32 v44, 0xffff0000, v41
    v_and_b32 v45, 0xffff0000, v42
    v_and_b32 v46, 0xffff0000, v43
    v_fma_f32 v44, s64, v44, v45
    v_mul_f32 v45, v44, v44
    v_fmamk_f32 v45, v45, 0xbdd2d3e8, v48
    v_mul_f32 v45, v45, v44
    v_exp_f32 v45, v45
    s_nop 0
    v_add_f32 v45, 1.0, v45
    v_rcp_f32 v45, v45
    s_nop 0
    v_mul_f32 v44, v44, v45
    v_fmac_f32 v40, v44, v46
    v_accvgpr_read_b32 v41, a20
    v_accvgpr_read_b32 v42, a56
    v_accvgpr_read_b32 v43, a92
    v_lshlrev_b32 v44, 16, v41
    v_lshlrev_b32 v45, 16, v42
    v_lshlrev_b32 v46, 16, v43
    v_fma_f32 v44, s64, v44, v45
    v_mul_f32 v45, v44, v44
    v_fmamk_f32 v45, v45, 0xbdd2d3e8, v48
    v_mul_f32 v45, v45, v44
    v_exp_f32 v45, v45
    s_nop 0
    v_add_f32 v45, 1.0, v45
    v_rcp_f32 v45, v45
    s_nop 0
    v_mul_f32 v44, v44, v45
    v_fmac_f32 v40, v44, v46
    v_and_b32 v44, 0xffff0000, v41
    v_and_b32 v45, 0xffff0000, v42
    v_and_b32 v46, 0xffff0000, v43
    v_fma_f32 v44, s64, v44, v45
    v_mul_f32 v45, v44, v44
    v_fmamk_f32 v45, v45, 0xbdd2d3e8, v48
    v_mul_f32 v45, v45, v44
    v_exp_f32 v45, v45
    s_nop 0
    v_add_f32 v45, 1.0, v45
    v_rcp_f32 v45, v45
    s_nop 0
    v_mul_f32 v44, v44, v45
    v_fmac_f32 v40, v44, v46
    v_accvgpr_read_b32 v41, a21
    v_accvgpr_read_b32 v42, a57
    v_accvgpr_read_b32 v43, a93
    v_lshlrev_b32 v44, 16, v41
    v_lshlrev_b32 v45, 16, v42
    v_lshlrev_b32 v46, 16, v43
    v_fma_f32 v44, s64, v44, v45
    v_mul_f32 v45, v44, v44
    v_fmamk_f32 v45, v45, 0xbdd2d3e8, v48
    v_mul_f32 v45, v45, v44
    v_exp_f32 v45, v45
    s_nop 0
    v_add_f32 v45, 1.0, v45
    v_rcp_f32 v45, v45
    s_nop 0
    v_mul_f32 v44, v44, v45
    v_fmac_f32 v40, v44, v46
    v_and_b32 v44, 0xffff0000, v41
    v_and_b32 v45, 0xffff0000, v42
    v_and_b32 v46, 0xffff0000, v43
    v_fma_f32 v44, s64, v44, v45
    v_mul_f32 v45, v44, v44
    v_fmamk_f32 v45, v45, 0xbdd2d3e8, v48
    v_mul_f32 v45, v45, v44
    v_exp_f32 v45, v45
    s_nop 0
    v_add_f32 v45, 1.0, v45
    v_rcp_f32 v45, v45
    s_nop 0
    v_mul_f32 v44, v44, v45
    v_fmac_f32 v40, v44, v46
    v_accvgpr_read_b32 v41, a22
    v_accvgpr_read_b32 v42, a58
    v_accvgpr_read_b32 v43, a94
    v_lshlrev_b32 v44, 16, v41
    v_lshlrev_b32 v45, 16, v42
    v_lshlrev_b32 v46, 16, v43
    v_fma_f32 v44, s64, v44, v45
    v_mul_f32 v45, v44, v44
    v_fmamk_f32 v45, v45, 0xbdd2d3e8, v48
    v_mul_f32 v45, v45, v44
    v_exp_f32 v45, v45
    s_nop 0
    v_add_f32 v45, 1.0, v45
    v_rcp_f32 v45, v45
    s_nop 0
    v_mul_f32 v44, v44, v45
    v_fmac_f32 v40, v44, v46
    v_and_b32 v44, 0xffff0000, v41
    v_and_b32 v45, 0xffff0000, v42
    v_and_b32 v46, 0xffff0000, v43
    v_fma_f32 v44, s64, v44, v45
    v_mul_f32 v45, v44, v44
    v_fmamk_f32 v45, v45, 0xbdd2d3e8, v48
    v_mul_f32 v45, v45, v44
    v_exp_f32 v45, v45
    s_nop 0
    v_add_f32 v45, 1.0, v45
    v_rcp_f32 v45, v45
    s_nop 0
    v_mul_f32 v44, v44, v45
    v_fmac_f32 v40, v44, v46
    v_accvgpr_read_b32 v41, a23
    v_accvgpr_read_b32 v42, a59
    v_accvgpr_read_b32 v43, a95
    v_lshlrev_b32 v44, 16, v41
    v_lshlrev_b32 v45, 16, v42
    v_lshlrev_b32 v46, 16, v43
    v_fma_f32 v44, s64, v44, v45
    v_mul_f32 v45, v44, v44
    v_fmamk_f32 v45, v45, 0xbdd2d3e8, v48
    v_mul_f32 v45, v45, v44
    v_exp_f32 v45, v45
    s_nop 0
    v_add_f32 v45, 1.0, v45
    v_rcp_f32 v45, v45
    s_nop 0
    v_mul_f32 v44, v44, v45
    v_fmac_f32 v40, v44, v46
    v_and_b32 v44, 0xffff0000, v41
    v_and_b32 v45, 0xffff0000, v42
    v_and_b32 v46, 0xffff0000, v43
    v_fma_f32 v44, s64, v44, v45
    v_mul_f32 v45, v44, v44
    v_fmamk_f32 v45, v45, 0xbdd2d3e8, v48
    v_mul_f32 v45, v45, v44
    v_exp_f32 v45, v45
    s_nop 0
    v_add_f32 v45, 1.0, v45
    v_rcp_f32 v45, v45
    s_nop 0
    v_mul_f32 v44, v44, v45
    v_fmac_f32 v40, v44, v46
    v_accvgpr_read_b32 v41, a24
    v_accvgpr_read_b32 v42, a60
    v_accvgpr_read_b32 v43, a96
    v_lshlrev_b32 v44, 16, v41
    v_lshlrev_b32 v45, 16, v42
    v_lshlrev_b32 v46, 16, v43
    v_fma_f32 v44, s64, v44, v45
    v_mul_f32 v45, v44, v44
    v_fmamk_f32 v45, v45, 0xbdd2d3e8, v48
    v_mul_f32 v45, v45, v44
    v_exp_f32 v45, v45
    s_nop 0
    v_add_f32 v45, 1.0, v45
    v_rcp_f32 v45, v45
    s_nop 0
    v_mul_f32 v44, v44, v45
    v_fmac_f32 v40, v44, v46
    v_and_b32 v44, 0xffff0000, v41
    v_and_b32 v45, 0xffff0000, v42
    v_and_b32 v46, 0xffff0000, v43
    v_fma_f32 v44, s64, v44, v45
    v_mul_f32 v45, v44, v44
    v_fmamk_f32 v45, v45, 0xbdd2d3e8, v48
    v_mul_f32 v45, v45, v44
    v_exp_f32 v45, v45
    s_nop 0
    v_add_f32 v45, 1.0, v45
    v_rcp_f32 v45, v45
    s_nop 0
    v_mul_f32 v44, v44, v45
    v_fmac_f32 v40, v44, v46
    v_accvgpr_read_b32 v41, a25
    v_accvgpr_read_b32 v42, a61
    v_accvgpr_read_b32 v43, a97
    v_lshlrev_b32 v44, 16, v41
    v_lshlrev_b32 v45, 16, v42
    v_lshlrev_b32 v46, 16, v43
    v_fma_f32 v44, s64, v44, v45
    v_mul_f32 v45, v44, v44
    v_fmamk_f32 v45, v45, 0xbdd2d3e8, v48
    v_mul_f32 v45, v45, v44
    v_exp_f32 v45, v45
    s_nop 0
    v_add_f32 v45, 1.0, v45
    v_rcp_f32 v45, v45
    s_nop 0
    v_mul_f32 v44, v44, v45
    v_fmac_f32 v40, v44, v46
    v_and_b32 v44, 0xffff0000, v41
    v_and_b32 v45, 0xffff0000, v42
    v_and_b32 v46, 0xffff0000, v43
    v_fma_f32 v44, s64, v44, v45
    v_mul_f32 v45, v44, v44
    v_fmamk_f32 v45, v45, 0xbdd2d3e8, v48
    v_mul_f32 v45, v45, v44
    v_exp_f32 v45, v45
    s_nop 0
    v_add_f32 v45, 1.0, v45
    v_rcp_f32 v45, v45
    s_nop 0
    v_mul_f32 v44, v44, v45
    v_fmac_f32 v40, v44, v46
    v_accvgpr_read_b32 v41, a26
    v_accvgpr_read_b32 v42, a62
    v_accvgpr_read_b32 v43, a98
    v_lshlrev_b32 v44, 16, v41
    v_lshlrev_b32 v45, 16, v42
    v_lshlrev_b32 v46, 16, v43
    v_fma_f32 v44, s64, v44, v45
    v_mul_f32 v45, v44, v44
    v_fmamk_f32 v45, v45, 0xbdd2d3e8, v48
    v_mul_f32 v45, v45, v44
    v_exp_f32 v45, v45
    s_nop 0
    v_add_f32 v45, 1.0, v45
    v_rcp_f32 v45, v45
    s_nop 0
    v_mul_f32 v44, v44, v45
    v_fmac_f32 v40, v44, v46
    v_and_b32 v44, 0xffff0000, v41
    v_and_b32 v45, 0xffff0000, v42
    v_and_b32 v46, 0xffff0000, v43
    v_fma_f32 v44, s64, v44, v45
    v_mul_f32 v45, v44, v44
    v_fmamk_f32 v45, v45, 0xbdd2d3e8, v48
    v_mul_f32 v45, v45, v44
    v_exp_f32 v45, v45
    s_nop 0
    v_add_f32 v45, 1.0, v45
    v_rcp_f32 v45, v45
    s_nop 0
    v_mul_f32 v44, v44, v45
    v_fmac_f32 v40, v44, v46
    v_accvgpr_read_b32 v41, a27
    v_accvgpr_read_b32 v42, a63
    v_accvgpr_read_b32 v43, a99
    v_lshlrev_b32 v44, 16, v41
    v_lshlrev_b32 v45, 16, v42
    v_lshlrev_b32 v46, 16, v43
    v_fma_f32 v44, s64, v44, v45
    v_mul_f32 v45, v44, v44
    v_fmamk_f32 v45, v45, 0xbdd2d3e8, v48
    v_mul_f32 v45, v45, v44
    v_exp_f32 v45, v45
    s_nop 0
    v_add_f32 v45, 1.0, v45
    v_rcp_f32 v45, v45
    s_nop 0
    v_mul_f32 v44, v44, v45
    v_fmac_f32 v40, v44, v46
    v_and_b32 v44, 0xffff0000, v41
    v_and_b32 v45, 0xffff0000, v42
    v_and_b32 v46, 0xffff0000, v43
    v_fma_f32 v44, s64, v44, v45
    v_mul_f32 v45, v44, v44
    v_fmamk_f32 v45, v45, 0xbdd2d3e8, v48
    v_mul_f32 v45, v45, v44
    v_exp_f32 v45, v45
    s_nop 0
    v_add_f32 v45, 1.0, v45
    v_rcp_f32 v45, v45
    s_nop 0
    v_mul_f32 v44, v44, v45
    v_fmac_f32 v40, v44, v46
    v_accvgpr_read_b32 v41, a28
    v_accvgpr_read_b32 v42, a64
    v_accvgpr_read_b32 v43, a100
    v_lshlrev_b32 v44, 16, v41
    v_lshlrev_b32 v45, 16, v42
    v_lshlrev_b32 v46, 16, v43
    v_fma_f32 v44, s64, v44, v45
    v_mul_f32 v45, v44, v44
    v_fmamk_f32 v45, v45, 0xbdd2d3e8, v48
    v_mul_f32 v45, v45, v44
    v_exp_f32 v45, v45
    s_nop 0
    v_add_f32 v45, 1.0, v45
    v_rcp_f32 v45, v45
    s_nop 0
    v_mul_f32 v44, v44, v45
    v_fmac_f32 v40, v44, v46
    v_and_b32 v44, 0xffff0000, v41
    v_and_b32 v45, 0xffff0000, v42
    v_and_b32 v46, 0xffff0000, v43
    v_fma_f32 v44, s64, v44, v45
    v_mul_f32 v45, v44, v44
    v_fmamk_f32 v45, v45, 0xbdd2d3e8, v48
    v_mul_f32 v45, v45, v44
    v_exp_f32 v45, v45
    s_nop 0
    v_add_f32 v45, 1.0, v45
    v_rcp_f32 v45, v45
    s_nop 0
    v_mul_f32 v44, v44, v45
    v_fmac_f32 v40, v44, v46
    v_accvgpr_read_b32 v41, a29
    v_accvgpr_read_b32 v42, a65
    v_accvgpr_read_b32 v43, a101
    v_lshlrev_b32 v44, 16, v41
    v_lshlrev_b32 v45, 16, v42
    v_lshlrev_b32 v46, 16, v43
    v_fma_f32 v44, s64, v44, v45
    v_mul_f32 v45, v44, v44
    v_fmamk_f32 v45, v45, 0xbdd2d3e8, v48
    v_mul_f32 v45, v45, v44
    v_exp_f32 v45, v45
    s_nop 0
    v_add_f32 v45, 1.0, v45
    v_rcp_f32 v45, v45
    s_nop 0
    v_mul_f32 v44, v44, v45
    v_fmac_f32 v40, v44, v46
    v_and_b32 v44, 0xffff0000, v41
    v_and_b32 v45, 0xffff0000, v42
    v_and_b32 v46, 0xffff0000, v43
    v_fma_f32 v44, s64, v44, v45
    v_mul_f32 v45, v44, v44
    v_fmamk_f32 v45, v45, 0xbdd2d3e8, v48
    v_mul_f32 v45, v45, v44
    v_exp_f32 v45, v45
    s_nop 0
    v_add_f32 v45, 1.0, v45
    v_rcp_f32 v45, v45
    s_nop 0
    v_mul_f32 v44, v44, v45
    v_fmac_f32 v40, v44, v46
    v_accvgpr_read_b32 v41, a30
    v_accvgpr_read_b32 v42, a66
    v_accvgpr_read_b32 v43, a102
    v_lshlrev_b32 v44, 16, v41
    v_lshlrev_b32 v45, 16, v42
    v_lshlrev_b32 v46, 16, v43
    v_fma_f32 v44, s64, v44, v45
    v_mul_f32 v45, v44, v44
    v_fmamk_f32 v45, v45, 0xbdd2d3e8, v48
    v_mul_f32 v45, v45, v44
    v_exp_f32 v45, v45
    s_nop 0
    v_add_f32 v45, 1.0, v45
    v_rcp_f32 v45, v45
    s_nop 0
    v_mul_f32 v44, v44, v45
    v_fmac_f32 v40, v44, v46
    v_and_b32 v44, 0xffff0000, v41
    v_and_b32 v45, 0xffff0000, v42
    v_and_b32 v46, 0xffff0000, v43
    v_fma_f32 v44, s64, v44, v45
    v_mul_f32 v45, v44, v44
    v_fmamk_f32 v45, v45, 0xbdd2d3e8, v48
    v_mul_f32 v45, v45, v44
    v_exp_f32 v45, v45
    s_nop 0
    v_add_f32 v45, 1.0, v45
    v_rcp_f32 v45, v45
    s_nop 0
    v_mul_f32 v44, v44, v45
    v_fmac_f32 v40, v44, v46
    v_accvgpr_read_b32 v41, a31
    v_accvgpr_read_b32 v42, a67
    v_accvgpr_read_b32 v43, a103
    v_lshlrev_b32 v44, 16, v41
    v_lshlrev_b32 v45, 16, v42
    v_lshlrev_b32 v46, 16, v43
    v_fma_f32 v44, s64, v44, v45
    v_mul_f32 v45, v44, v44
    v_fmamk_f32 v45, v45, 0xbdd2d3e8, v48
    v_mul_f32 v45, v45, v44
    v_exp_f32 v45, v45
    s_nop 0
    v_add_f32 v45, 1.0, v45
    v_rcp_f32 v45, v45
    s_nop 0
    v_mul_f32 v44, v44, v45
    v_fmac_f32 v40, v44, v46
    v_and_b32 v44, 0xffff0000, v41
    v_and_b32 v45, 0xffff0000, v42
    v_and_b32 v46, 0xffff0000, v43
    v_fma_f32 v44, s64, v44, v45
    v_mul_f32 v45, v44, v44
    v_fmamk_f32 v45, v45, 0xbdd2d3e8, v48
    v_mul_f32 v45, v45, v44
    v_exp_f32 v45, v45
    s_nop 0
    v_add_f32 v45, 1.0, v45
    v_rcp_f32 v45, v45
    s_nop 0
    v_mul_f32 v44, v44, v45
    v_fmac_f32 v40, v44, v46
    v_accvgpr_read_b32 v41, a32
    v_accvgpr_read_b32 v42, a68
    v_accvgpr_read_b32 v43, a104
    v_lshlrev_b32 v44, 16, v41
    v_lshlrev_b32 v45, 16, v42
    v_lshlrev_b32 v46, 16, v43
    v_fma_f32 v44, s64, v44, v45
    v_mul_f32 v45, v44, v44
    v_fmamk_f32 v45, v45, 0xbdd2d3e8, v48
    v_mul_f32 v45, v45, v44
    v_exp_f32 v45, v45
    s_nop 0
    v_add_f32 v45, 1.0, v45
    v_rcp_f32 v45, v45
    s_nop 0
    v_mul_f32 v44, v44, v45
    v_fmac_f32 v40, v44, v46
    v_and_b32 v44, 0xffff0000, v41
    v_and_b32 v45, 0xffff0000, v42
    v_and_b32 v46, 0xffff0000, v43
    v_fma_f32 v44, s64, v44, v45
    v_mul_f32 v45, v44, v44
    v_fmamk_f32 v45, v45, 0xbdd2d3e8, v48
    v_mul_f32 v45, v45, v44
    v_exp_f32 v45, v45
    s_nop 0
    v_add_f32 v45, 1.0, v45
    v_rcp_f32 v45, v45
    s_nop 0
    v_mul_f32 v44, v44, v45
    v_fmac_f32 v40, v44, v46
    v_accvgpr_read_b32 v41, a33
    v_accvgpr_read_b32 v42, a69
    v_accvgpr_read_b32 v43, a105
    v_lshlrev_b32 v44, 16, v41
    v_lshlrev_b32 v45, 16, v42
    v_lshlrev_b32 v46, 16, v43
    v_fma_f32 v44, s64, v44, v45
    v_mul_f32 v45, v44, v44
    v_fmamk_f32 v45, v45, 0xbdd2d3e8, v48
    v_mul_f32 v45, v45, v44
    v_exp_f32 v45, v45
    s_nop 0
    v_add_f32 v45, 1.0, v45
    v_rcp_f32 v45, v45
    s_nop 0
    v_mul_f32 v44, v44, v45
    v_fmac_f32 v40, v44, v46
    v_and_b32 v44, 0xffff0000, v41
    v_and_b32 v45, 0xffff0000, v42
    v_and_b32 v46, 0xffff0000, v43
    v_fma_f32 v44, s64, v44, v45
    v_mul_f32 v45, v44, v44
    v_fmamk_f32 v45, v45, 0xbdd2d3e8, v48
    v_mul_f32 v45, v45, v44
    v_exp_f32 v45, v45
    s_nop 0
    v_add_f32 v45, 1.0, v45
    v_rcp_f32 v45, v45
    s_nop 0
    v_mul_f32 v44, v44, v45
    v_fmac_f32 v40, v44, v46
    v_accvgpr_read_b32 v41, a34
    v_accvgpr_read_b32 v42, a70
    v_accvgpr_read_b32 v43, a106
    v_lshlrev_b32 v44, 16, v41
    v_lshlrev_b32 v45, 16, v42
    v_lshlrev_b32 v46, 16, v43
    v_fma_f32 v44, s64, v44, v45
    v_mul_f32 v45, v44, v44
    v_fmamk_f32 v45, v45, 0xbdd2d3e8, v48
    v_mul_f32 v45, v45, v44
    v_exp_f32 v45, v45
    s_nop 0
    v_add_f32 v45, 1.0, v45
    v_rcp_f32 v45, v45
    s_nop 0
    v_mul_f32 v44, v44, v45
    v_fmac_f32 v40, v44, v46
    v_and_b32 v44, 0xffff0000, v41
    v_and_b32 v45, 0xffff0000, v42
    v_and_b32 v46, 0xffff0000, v43
    v_fma_f32 v44, s64, v44, v45
    v_mul_f32 v45, v44, v44
    v_fmamk_f32 v45, v45, 0xbdd2d3e8, v48
    v_mul_f32 v45, v45, v44
    v_exp_f32 v45, v45
    s_nop 0
    v_add_f32 v45, 1.0, v45
    v_rcp_f32 v45, v45
    s_nop 0
    v_mul_f32 v44, v44, v45
    v_fmac_f32 v40, v44, v46
    v_accvgpr_read_b32 v41, a35
    v_accvgpr_read_b32 v42, a71
    v_accvgpr_read_b32 v43, a107
    v_lshlrev_b32 v44, 16, v41
    v_lshlrev_b32 v45, 16, v42
    v_lshlrev_b32 v46, 16, v43
    v_fma_f32 v44, s64, v44, v45
    v_mul_f32 v45, v44, v44
    v_fmamk_f32 v45, v45, 0xbdd2d3e8, v48
    v_mul_f32 v45, v45, v44
    v_exp_f32 v45, v45
    s_nop 0
    v_add_f32 v45, 1.0, v45
    v_rcp_f32 v45, v45
    s_nop 0
    v_mul_f32 v44, v44, v45
    v_fmac_f32 v40, v44, v46
    v_and_b32 v44, 0xffff0000, v41
    v_and_b32 v45, 0xffff0000, v42
    v_and_b32 v46, 0xffff0000, v43
    v_fma_f32 v44, s64, v44, v45
    v_mul_f32 v45, v44, v44
    v_fmamk_f32 v45, v45, 0xbdd2d3e8, v48
    v_mul_f32 v45, v45, v44
    v_exp_f32 v45, v45
    s_nop 0
    v_add_f32 v45, 1.0, v45
    v_rcp_f32 v45, v45
    s_nop 0
    v_mul_f32 v44, v44, v45
    v_fmac_f32 v40, v44, v46
    s_nop 1
    v_add_f32_dpp v40, v40, v40 quad_perm:[1,0,3,2] row_mask:0xf bank_mask:0xf
    s_nop 1
    v_add_f32_dpp v40, v40, v40 quad_perm:[2,3,0,1] row_mask:0xf bank_mask:0xf
    s_nop 1
    v_add_f32_dpp v40, v40, v40 row_half_mirror row_mask:0xf bank_mask:0xf
    s_nop 1
    v_add_f32_dpp v40, v40, v40 row_mirror row_mask:0xf bank_mask:0xf
    v_mov_b32 v41, v40
    s_nop 1
    v_permlane16_swap_b32 v40, v41
    v_add_f32 v40, v40, v41
    v_mov_b32 v41, v40
    s_nop 1
    v_permlane32_swap_b32 v40, v41
    v_add_f32 v40, v40, v41
    v_cvt_pk_bf16_f32 v40, v40, v40
    v_and_b32 v40, 0xffff0000, v40
    v_add_f32 v40, s68, v40
    v_cvt_pk_bf16_f32 v40, v40, v40
    v_and_b32 v40, 0xffff0000, v40
    s_setpc_b64 s[90:91]
.section .rodata,"a"
.p2align 6
.amdhsa_kernel sequential_preLN__gqa_block_cached__mixer_token_mlp__decode_kernel
  .amdhsa_next_free_vgpr 256
  .amdhsa_next_free_sgpr 96
  .amdhsa_accum_offset 128
  .amdhsa_group_segment_fixed_size 0
  .amdhsa_kernarg_size 104
  .amdhsa_user_sgpr_count 2
  .amdhsa_user_sgpr_kernarg_segment_ptr 1
  .amdhsa_system_sgpr_workgroup_id_x 1
  .amdhsa_float_denorm_mode_32 3
.end_amdhsa_kernel
```
